```python
import torch

def _softmax(x, axis=-1):
    return torch.softmax(x, dim=axis)

def _gelu(x):
    return torch.nn.functional.gelu(x, approximate='tanh')

def _silu(x):
    return torch.nn.functional.silu(x)

def _sigmoid(x):
    return torch.sigmoid(x)

def _layernorm(x, axis=-1, eps=1e-05):
    m = x.mean(dim=axis, keepdim=True)
    v = x.var(dim=axis, keepdim=True, unbiased=False)
    return (x - m) / torch.sqrt(v + eps)

def _scatter_add(tgt, idx, src, axis=0):
    return tgt.clone().index_add_(axis, idx, src)

def _segment_sum(src, seg, n):
    out = torch.zeros((n,) + src.shape[1:], dtype=src.dtype)
    return out.index_add_(0, seg, src)

def _pad(x, pw):
    flat = tuple((v for pair in reversed(pw) for v in pair))
    return torch.nn.functional.pad(x, flat)
kernel_name = 'adaLN_cond__sliding_block_cached__glu_gated_reglu__decode'

def setup_inputs():

    _w = lambda a: (lambda t: t.to(torch.bfloat16) if t.is_floating_point() else t)(torch.as_tensor(a))

    def _A_setup():
        B, Sq, D = (2, 1, 512)
        Hq, Hkv, Sk, Dh = (32, 8, 8192, 128)
        assert Hq % Hkv == 0, (Hq, Hkv)
        return {'x': _w((lambda *s: torch.randn(*s, dtype=torch.bfloat16) * 0.1)(B, Sq, D)), 'k_cache': _w((lambda *s: torch.randn(*s, dtype=torch.bfloat16) * 0.8)(B, Hkv, Sk, Dh)), 'v_cache': _w((lambda *s: torch.randn(*s, dtype=torch.bfloat16) * 3.2)(B, Hkv, Sk, Dh)), 'wq': _w((lambda *s: torch.randn(*s, dtype=torch.bfloat16) * 0.8)(D, Hq * Dh) * D ** (-0.5)), 'wo': _w((lambda *s: torch.randn(*s, dtype=torch.bfloat16) * 3.2)(Hq * Dh, D) * (Hq * Dh) ** (-0.5))}
    _A_in = _A_setup()

    def _B_setup():
        B, S, D, F = (2, 1, 512, 1792)
        return {'x': _w((lambda *s: torch.randn(*s, dtype=torch.bfloat16) * 0.1)(B, S, D)), 'W_gate': _w((lambda *s: torch.randn(*s, dtype=torch.bfloat16) * 3.2)(D, F) * (2.0 / D) ** 0.5), 'W_up': _w((lambda *s: torch.randn(*s, dtype=torch.bfloat16) * 3.2)(D, F) * (2.0 / D) ** 0.5), 'W_down': _w((lambda *s: torch.randn(*s, dtype=torch.bfloat16) * 3.2)(F, D) * (1.0 / F) ** 0.5)}
    _B_in = _B_setup()
    return {'A_x': _A_in['x'], 'A_k_cache': _A_in['k_cache'], 'A_v_cache': _A_in['v_cache'], 'A_wq': _A_in['wq'], 'A_wo': _A_in['wo'], 'B_x': _B_in['x'], 'B_W_gate': _B_in['W_gate'], 'B_W_up': _B_in['W_up'], 'B_W_down': _B_in['W_down'], 'c': _w((lambda *s: torch.randn(*s, dtype=torch.bfloat16) * 0.1)(2, 512) * 8.0), 'w_mod': _w((lambda *s: torch.randn(*s, dtype=torch.bfloat16) * 0.1)(512, 6 * 512) * 512 ** (-0.5) * 8.0)}

def reference(A_x, A_k_cache, A_v_cache, A_wq, A_wo, B_x, B_W_gate, B_W_up, B_W_down, c, w_mod):

    def _A_ref(x, k_cache, v_cache, wq, wo):
        B, Sq, D = x.shape
        Hq, Dh = (32, 128)
        Hkv, Sk = (k_cache.shape[1], k_cache.shape[2])
        W = min(4096, max(256, Sk // 4))
        rep = Hq // Hkv
        q = (lambda x, *d: x.permute(*d))((x @ wq).reshape(B, Sq, Hq, Dh), 0, 2, 1, 3)
        k = (lambda x, n, axis: torch.repeat_interleave(x, n, dim=axis))(k_cache[:, :, Sk - W:, :], rep, axis=1)
        v = (lambda x, n, axis: torch.repeat_interleave(x, n, dim=axis))(v_cache[:, :, Sk - W:, :], rep, axis=1)
        scores = torch.einsum('bhqd,bhkd->bhqk', q, k) * Dh ** (-0.5)
        p = _softmax(scores, axis=-1)
        o = torch.einsum('bhqk,bhkd->bhqd', p, v)
        return (lambda x, *d: x.permute(*d))(o, 0, 2, 1, 3).reshape(B, Sq, Hq * Dh) @ wo

    def _B_ref(x, W_gate, W_up, W_down):
        gate = torch.einsum('bsd,df->bsf', x, W_gate)
        up = torch.einsum('bsd,df->bsf', x, W_up)
        gate = gate * (lambda x, dt: x.to(dt))(gate > 0, gate.dtype)
        h = gate * up
        return torch.einsum('bsf,fd->bsd', h, W_down)
    x = A_x
    mod = (_silu(c) @ w_mod).reshape(c.shape[0], 6, 1, -1)
    sa, ca, ga, sb, cb, gb = (mod[:, 0].clone(), mod[:, 1].clone(), mod[:, 2].clone(), mod[:, 3].clone(), mod[:, 4].clone(), mod[:, 5].clone())
    h = _layernorm(x, axis=-1) * (1 + ca) + sa
    x = x + ga * _A_ref(h, A_k_cache, A_v_cache, A_wq, A_wo)
    h = _layernorm(x, axis=-1) * (1 + cb) + sb
    x = x + gb * _B_ref(h, B_W_gate, B_W_up, B_W_down)
    return x
```

```asm
; @launch grid=(256,1,1) block=(320,1,1) lds=151552
.amdgcn_target "amdgcn-amd-amdhsa--gfx950"
.text
.globl adaLN_cond__sliding_block_cached__glu_gated_reglu__decode_kernel
.p2align 12
.type adaLN_cond__sliding_block_cached__glu_gated_reglu__decode_kernel,@function
adaLN_cond__sliding_block_cached__glu_gated_reglu__decode_kernel:
    s_cmp_ge_u32 s2, 256
    s_cbranch_scc1 Lexit
    s_load_dwordx16 s[16:31], s[0:1], 0
    s_load_dwordx8 s[32:39], s[0:1], 64
    s_load_dwordx2 s[40:41], s[0:1], 104
    s_getpc_b64 s[56:57]
Lpc0:
    s_lshr_b32 s5, s2, 3
    v_lshrrev_b32 v1, 6, v0
    s_mul_i32 s6, s5, 640
    v_lshl_add_u32 v2, v1, 7, s6
    v_min_u32 v2, Lcode_end-Lpc0-4, v2
    global_load_dword v239, v2, s[56:57]
    v_and_b32 v0, 63, v0
    s_and_b32 s4, s2, 7
    v_readfirstlane_b32 s3, v1
    s_mov_b32 s42, 2097152
    s_mov_b32 s43, 0x20000
    s_mov_b32 s47, 0x20000
    s_mov_b32 s51, 0x20000
    s_lshl_b32 s7, s3, 14
    s_cmp_ge_u32 s5, 24
    s_cbranch_scc1 LG0
    s_cmp_eq_u32 s3, 4
    s_cbranch_scc1 LH0
    v_lshrrev_b32 v1, 4, v0
    v_and_b32 v8, 15, v0
    v_lshlrev_b32 v6, 1, v1
    v_xor_b32 v6, v8, v6
    v_lshlrev_b32 v6, 4, v6
    v_lshl_add_u32 v6, v1, 8, v6
    v_xor_b32 v7, 0x80, v6
    s_mov_b32 m0, s7
    s_cmp_ge_u32 s5, 16
    s_cbranch_scc0 LT0
LW0:
    s_lshl_b32 s9, s4, 19
    s_and_b32 s52, s5, 7
    s_lshl_b32 s15, s52, 10
    s_add_u32 s9, s9, s15
    s_lshl_b32 s15, s3, 8
    s_add_u32 s9, s9, s15
    v_mul_u32_u24 v2, 0x1f00, v1
    v_add_u32 v6, v6, v2
    v_add_u32 v7, v7, v2
    s_add_u32 s13, s7, 16384
    s_mov_b32 s46, 4194304
    s_waitcnt lgkmcnt(0)
    s_mov_b64 s[44:45], s[22:23]
    s_load_dword s14, s[40:41], 0
LWq:
    buffer_load_dwordx4 v6, s[44:47], s9 offen nt lds
    s_add_u32 m0, m0, 1024
    s_add_u32 s9, s9, 32768
    buffer_load_dwordx4 v7, s[44:47], s9 offen nt lds
    s_add_u32 m0, m0, 1024
    s_add_u32 s9, s9, 32768
    s_waitcnt vmcnt(8)
    s_cmp_lt_u32 m0, s13
    s_cbranch_scc1 LWq
    s_branch LW2
LH0:
    s_cmp_ge_u32 s5, 16
    s_cbranch_scc0 LTH
    s_branch LWHp
LG0:
    s_sub_u32 s5, s5, 24
    s_mov_b32 s60, s4
    s_mov_b32 s61, s5
    s_mov_b32 s50, 2048
    s_cmp_eq_u32 s3, 4
    s_cbranch_scc0 LGW
    v_bfe_u32 v4, v0, 4, 1
    v_lshlrev_b32 v4, 10, v4
    v_and_b32 v11, 15, v0
    v_lshl_add_u32 v4, v11, 3, v4
    s_lshl_b32 s9, s61, 7
    s_waitcnt lgkmcnt(0)
    s_mov_b64 s[48:49], s[34:35]
    buffer_load_dwordx2 v[28:29], v4, s[48:51], s9 offen
    s_load_dword s14, s[40:41], 0
    v_bfe_u32 v10, v0, 4, 1
    v_mul_u32_u24 v5, 144, v10
    v_bfe_u32 v4, v0, 3, 1
    v_lshl_add_u32 v5, v4, 6, v5
    v_and_b32 v4, 3, v0
    v_lshl_add_u32 v5, v4, 4, v5
    v_bfe_u32 v4, v0, 2, 1
    v_lshl_add_u32 v5, v4, 3, v5
    v_add_u32 v5, 147456, v5
    s_waitcnt vmcnt(0)
    v_lshlrev_b32 v16, 16, v28
    v_and_b32 v17, 0xffff0000, v28
    v_lshlrev_b32 v18, 16, v29
    v_and_b32 v19, 0xffff0000, v29
    v_mul_f32 v24, 0xbfb8aa3b, v16
    v_mul_f32 v25, 0xbfb8aa3b, v17
    v_mul_f32 v26, 0xbfb8aa3b, v18
    v_mul_f32 v27, 0xbfb8aa3b, v19
    v_exp_f32 v24, v24
    v_exp_f32 v25, v25
    v_exp_f32 v26, v26
    v_exp_f32 v27, v27
    v_add_f32 v24, 1.0, v24
    v_add_f32 v25, 1.0, v25
    v_add_f32 v26, 1.0, v26
    v_add_f32 v27, 1.0, v27
    v_rcp_f32 v24, v24
    v_rcp_f32 v25, v25
    v_rcp_f32 v26, v26
    v_rcp_f32 v27, v27
    v_mul_f32 v16, v16, v24
    v_mul_f32 v17, v17, v25
    v_mul_f32 v18, v18, v26
    v_mul_f32 v19, v19, v27
    v_cvt_pk_bf16_f32 v28, v16, v17
    v_cvt_pk_bf16_f32 v29, v18, v19
    ds_write_b64 v5, v[28:29]
    s_waitcnt lgkmcnt(0)
    s_barrier
    s_barrier
    s_branch LGH2
LGW:
    v_lshlrev_b32 v6, 4, v0
    v_lshrrev_b32 v1, 3, v0
    v_and_b32 v2, 6, v1
    v_and_b32 v3, 7, v0
    v_xor_b32 v2, v2, v3
    v_mul_u32_u24 v1, 6144, v1
    v_lshl_add_u32 v2, v2, 4, v1
    s_lshl_b32 s9, s61, 2
    s_add_u32 s9, s9, s3
    s_mul_i32 s9, s9, 98304
    s_lshl_b32 s6, s60, 7
    s_add_u32 s9, s9, s6
    s_lshl_b32 s13, s3, 5
    s_add_u32 s6, s6, s13
    v_and_b32 v12, 1, v0
    v_and_b32 v13, 48, v0
    v_lshrrev_b32 v4, 1, v13
    v_lshl_add_u32 v4, v12, 10, v4
    v_lshrrev_b32 v14, 5, v0
    v_lshlrev_b32 v14, 10, v14
    v_and_b32 v15, 31, v0
    v_lshl_add_u32 v14, v15, 3, v14
    s_lshl_b32 s63, s3, 8
    s_lshr_b32 m0, s7, 2
    s_mov_b32 s54, 3145728
    s_mov_b32 s55, 0x20000
    s_lshl_b32 s8, s60, 12
    s_lshl_b32 s15, s3, 10
    s_add_u32 s8, s8, s15
    s_lshl_b32 s15, s61, 7
    s_add_u32 s8, s8, s15
    s_add_u32 s8, s8, 32768
    s_add_u32 s62, s8, 32768
    s_waitcnt lgkmcnt(0)
    s_mov_b64 s[48:49], s[16:17]
    s_mov_b64 s[52:53], s[36:37]
    buffer_load_dwordx2 v[24:25], v14, s[48:51], s63 offen
    s_mov_b32 exec_lo, 0x30003
    s_mov_b32 exec_hi, 0x30003
    buffer_load_dwordx2 v[20:21], v4, s[48:51], s6 offen
    s_mov_b64 exec, -1
    buffer_load_dwordx4 v2, s[52:55], s9 offen nt lds
    buffer_load_dwordx4 v2, s[52:55], s9 offen offset:1024 nt lds
    s_add_u32 m0, m0, 2048
    s_add_u32 s9, s9, 49152
    buffer_load_dwordx4 v2, s[52:55], s9 offen nt lds
    buffer_load_dwordx4 v2, s[52:55], s9 offen offset:1024 nt lds
    s_mov_b64 exec, 1
    buffer_load_dword v238, v6, s[40:43], s62 offen sc1
    s_mov_b64 exec, -1
    s_load_dword s14, s[40:41], 0
    v_bfe_u32 v1, v0, 2, 3
    v_bfe_u32 v8, v0, 3, 2
    v_lshlrev_b32 v8, 5, v8
    v_lshl_add_u32 v8, v1, 7, v8
    v_lshrrev_b32 v1, 5, v0
    v_lshl_add_u32 v8, v1, 11, v8
    v_and_b32 v3, 3, v0
    v_lshl_add_u32 v8, v3, 3, v8
    v_xor_b32 v8, s13, v8
    v_mul_u32_u24 v6, 144, v12
    v_add_u32 v6, v6, v13
    v_add_u32 v6, 147456, v6
    v_lshlrev_b32 v7, 4, v12
    v_lshl_add_u32 v13, v13, 1, v7
    s_cmp_eq_u32 s61, 0
    s_cselect_b32 s9, 1.0, 0
    v_mov_b32 v44, s9
    v_mov_b32 v45, s9
    v_mov_b32 v46, s9
    v_mov_b32 v47, s9
    s_mov_b32 s9, 0x3f803f80
    v_and_b32 v15, 48, v0
    s_lshl_b32 s15, s3, 2
    s_add_u32 s15, s15, 148480
    v_add_u32 v15, s15, v15
    v_lshlrev_b32 v7, 5, v12
    v_add_u32 v7, 148480, v7
    v_mov_b32 v52, 0x3727c5ac
    s_waitcnt vmcnt(5) lgkmcnt(0)
    s_mul_i32 s14, s14, 0x9E3779B1
    s_add_u32 s14, s14, 0x7F4A7C15
    v_dot2_f32_bf16 v48, v24, s9, 0
    v_dot2_f32_bf16 v50, v24, v24, 0
    v_dot2_f32_bf16 v48, v25, s9, v48
    v_dot2_f32_bf16 v50, v25, v25, v50
    v_lshlrev_b32 v16, 16, v20
    v_and_b32 v17, 0xffff0000, v20
    v_lshlrev_b32 v18, 16, v21
    v_and_b32 v19, 0xffff0000, v21
    v_permlane16_swap_b32 v48, v50
    v_add_f32 v48, v48, v50
    s_nop 1
    v_add_f32_dpp v48, v48, v48 quad_perm:[1,0,3,2] row_mask:0xf bank_mask:0xf
    s_nop 1
    v_add_f32_dpp v48, v48, v48 quad_perm:[2,3,0,1] row_mask:0xf bank_mask:0xf
    s_nop 1
    v_add_f32_dpp v48, v48, v48 row_half_mirror row_mask:0xf bank_mask:0xf
    s_nop 1
    v_add_f32_dpp v48, v48, v48 row_mirror row_mask:0xf bank_mask:0xf
    ds_write_b32 v15, v48
    s_waitcnt lgkmcnt(0)
    v_mov_b32 v58, s14
    v_mov_b32 v59, s14
    s_waitcnt vmcnt(1)
    s_barrier
    ds_read_b128 v[24:27], v7
    ds_read_b128 v[28:31], v7 offset:16
    ds_read_b128 v[32:35], v6 offset:0
    ds_read_b64_tr_b16 v[64:65], v8 offset:0
    ds_read_b64_tr_b16 v[66:67], v8 offset:4096
    ds_read_b64_tr_b16 v[68:69], v8 offset:1024
    ds_read_b64_tr_b16 v[70:71], v8 offset:5120
    ds_read_b128 v[36:39], v6 offset:64
    ds_read_b64_tr_b16 v[72:73], v8 offset:8192
    ds_read_b64_tr_b16 v[74:75], v8 offset:12288
    ds_read_b64_tr_b16 v[76:77], v8 offset:9216
    ds_read_b64_tr_b16 v[78:79], v8 offset:13312
    s_waitcnt lgkmcnt(10)
    v_pk_add_f32 v[24:25], v[24:25], v[26:27]
    v_pk_add_f32 v[28:29], v[28:29], v[30:31]
    v_add_f32 v50, v24, v25
    v_add_f32 v51, v28, v29
    v_mul_f32 v50, 0xbb000000, v50
    v_fmamk_f32 v51, v51, 0x3b000000, v52
    v_fma_f32 v51, -v50, v50, v51
    v_max_f32 v51, v51, v52
    v_rsq_f32 v51, v51
    s_nop 0
    v_pk_add_f32 v[16:17], v[16:17], v[50:51] op_sel_hi:[1,0]
    v_pk_add_f32 v[18:19], v[18:19], v[50:51] op_sel_hi:[1,0]
    v_pk_mul_f32 v[16:17], v[16:17], v[50:51] op_sel:[0,1] op_sel_hi:[1,1]
    v_pk_mul_f32 v[18:19], v[18:19], v[50:51] op_sel:[0,1] op_sel_hi:[1,1]
    s_waitcnt lgkmcnt(5)
    v_mfma_f32_16x16x32_bf16 v[40:43], v[64:67], v[32:35], 0
    v_mfma_f32_16x16x32_bf16 v[44:47], v[68:71], v[32:35], v[44:47]
    s_waitcnt lgkmcnt(0)
    v_mfma_f32_16x16x32_bf16 v[40:43], v[72:75], v[36:39], v[40:43]
    v_mfma_f32_16x16x32_bf16 v[44:47], v[76:79], v[36:39], v[44:47]
    s_mov_b32 exec_lo, 0x30003
    s_mov_b32 exec_hi, 0x30003
    s_nop 5
    v_pk_fma_f32 v[40:41], v[16:17], v[44:45], v[40:41]
    v_pk_fma_f32 v[42:43], v[18:19], v[46:47], v[42:43]
    v_cvt_pk_bf16_f32 v56, v40, v41
    v_cvt_pk_bf16_f32 v57, v42, v43
    buffer_store_dwordx4 v[56:59], v13, s[40:43], s62 offen
    s_barrier
    buffer_store_dwordx4 v[56:59], v13, s[40:43], s8 offen sc1
    s_mov_b64 exec, -1
    s_lshr_b32 s63, s7, 1
    s_add_u32 s63, s63, 114688
    s_mul_i32 s26, s4, 7
    s_add_u32 s26, s26, s5
    s_cmp_eq_u32 s5, 7
    s_cbranch_scc1 LO3
    s_cmp_lt_u32 s3, 0
    s_cbranch_scc1 LGn
    s_mul_i32 s9, s61, 393216
    s_lshl_b32 s15, s60, 9
    s_add_u32 s9, s9, s15
    s_lshl_b32 s15, s3, 7
    s_add_u32 s9, s9, s15
    s_add_u32 s9, s9, 2048
    s_mov_b32 m0, s63
    s_add_u32 s15, s63, 8192
Lmr1:
    buffer_load_dwordx4 v2, s[52:55], s9 offen nt lds
    s_add_u32 m0, m0, 1024
    s_add_u32 s9, s9, 49152
    s_cmp_lt_u32 m0, s15
    s_cbranch_scc1 Lmr1
LGn:
    s_mov_b64 s[92:93], s[20:21]
    s_mov_b32 s94, 33554432
    s_mov_b32 s95, 0x20000
    s_lshl_b32 s8, s5, 2
    s_add_u32 s8, s8, s3
    s_lshr_b32 s9, s8, 4
    s_lshl_b32 s9, s9, 3
    s_add_u32 s9, s9, s4
    s_lshl_b32 s9, s9, 21
    s_and_b32 s8, s8, 15
    s_lshl_b32 s8, s8, 15
    s_add_u32 s8, s8, s9
    s_add_u32 s8, s8, 1585152
    v_lshrrev_b32 v3, 5, v0
    v_and_b32 v4, 31, v0
    v_lshlrev_b32 v4, 7, v4
    v_lshl_add_u32 v3, v3, 14, v4
    s_mov_b32 exec_lo, 0xffff
    s_mov_b32 exec_hi, 0xffff
    buffer_load_dword v236, v3, s[92:95], s8 offen
    s_mov_b64 exec, -1
    s_sub_u32 s8, s8, 4096
    s_mov_b32 exec_lo, 0xffff0000
    s_mov_b32 exec_hi, 0xffff0000
    buffer_load_dword v237, v3, s[92:95], s8 offen
    s_mov_b64 exec, -1
    s_add_u32 s7, s7, 16384
    s_mov_b32 s53, s26
    v_mov_b32 v32, -1
    v_mov_b32 v33, -1
    v_mov_b32 v34, -1
    v_mov_b32 v35, -1
    v_lshrrev_b32 v3, 3, v0
    v_mul_u32_u24 v3, 7168, v3
    v_and_b32 v4, 7, v0
    v_lshl_add_u32 v3, v4, 4, v3
    s_mul_i32 s26, s3, 57344
    s_lshl_b32 s15, s53, 7
    s_add_u32 s26, s26, s15
    s_add_u32 s26, s26, 458752
    buffer_store_dwordx4 v[32:35], v3, s[40:43], s26 offen sc1
    s_and_b32 s52, s53, 0
    s_cmp_eq_u32 s52, 0
    s_cselect_b64 s[44:45], s[28:29], s[30:31]
    s_cselect_b64 s[48:49], s[30:31], s[28:29]
    s_mov_b32 s46, 1835008
    s_mov_b32 s50, 1835008
    s_lshl_b32 s52, s52, 13
    v_lshrrev_b32 v1, 2, v0
    v_bfe_u32 v2, v0, 4, 1
    v_lshlrev_b32 v2, 1, v2
    v_and_b32 v3, 3, v0
    v_xor_b32 v2, v2, v3
    v_mul_u32_u24 v4, 3584, v1
    v_lshl_add_u32 v2, v2, 4, v4
    s_mul_i32 s8, s3, 458752
    s_lshl_b32 s15, s53, 6
    s_add_u32 s8, s8, s15
    s_waitcnt vmcnt(0)
    s_barrier
    s_cmp_lt_u32 s3, 0
    s_cbranch_scc1 LGo
    v_bfe_u32 v5, v0, 2, 3
    v_bfe_u32 v8, v0, 3, 2
    v_lshlrev_b32 v8, 5, v8
    v_lshl_add_u32 v8, v5, 7, v8
    v_lshrrev_b32 v5, 5, v0
    v_lshl_add_u32 v8, v5, 10, v8
    v_and_b32 v6, 3, v0
    v_lshl_add_u32 v8, v6, 3, v8
    v_add_u32 v8, s63, v8
    v_xor_b32 v9, 32, v8
    v_xor_b32 v10, 64, v8
    v_xor_b32 v11, 96, v8
    v_and_b32 v5, 1, v0
    v_and_b32 v6, 48, v0
    v_mul_u32_u24 v7, 144, v5
    v_add_u32 v7, v7, v6
    v_add_u32 v7, 147456, v7
    v_lshlrev_b32 v5, 4, v5
    v_lshl_add_u32 v5, v6, 1, v5
    ds_read_b128 v[32:35], v7 offset:0
    ds_read_b128 v[36:39], v7 offset:64
    s_lshl_b32 s9, s60, 14
    s_lshl_b32 s15, s3, 12
    s_add_u32 s9, s9, s15
    s_lshl_b32 s15, s61, 7
    s_add_u32 s9, s9, s15
    s_add_u32 s9, s9, 851968
    s_waitcnt vmcnt(0)
    s_setprio 3
    ds_read_b64_tr_b16 v[64:65], v8 offset:0
    ds_read_b64_tr_b16 v[66:67], v8 offset:2048
    ds_read_b64_tr_b16 v[68:69], v9 offset:0
    ds_read_b64_tr_b16 v[70:71], v9 offset:2048
    ds_read_b64_tr_b16 v[72:73], v10 offset:0
    ds_read_b64_tr_b16 v[74:75], v10 offset:2048
    ds_read_b64_tr_b16 v[76:77], v11 offset:0
    ds_read_b64_tr_b16 v[78:79], v11 offset:2048
    ds_read_b64_tr_b16 v[80:81], v8 offset:4096
    ds_read_b64_tr_b16 v[82:83], v8 offset:6144
    ds_read_b64_tr_b16 v[84:85], v9 offset:4096
    ds_read_b64_tr_b16 v[86:87], v9 offset:6144
    ds_read_b64_tr_b16 v[88:89], v10 offset:4096
    ds_read_b64_tr_b16 v[90:91], v10 offset:6144
    ds_read_b64_tr_b16 v[92:93], v11 offset:4096
    ds_read_b64_tr_b16 v[94:95], v11 offset:6144
    s_waitcnt lgkmcnt(0)
    v_mfma_f32_16x16x32_bf16 v[40:43], v[64:67], v[32:35], 0
    v_mfma_f32_16x16x32_bf16 v[44:47], v[68:71], v[32:35], 0
    v_mfma_f32_16x16x32_bf16 v[48:51], v[72:75], v[32:35], 0
    v_mfma_f32_16x16x32_bf16 v[52:55], v[76:79], v[32:35], 0
    v_mfma_f32_16x16x32_bf16 v[40:43], v[80:83], v[36:39], v[40:43]
    v_mfma_f32_16x16x32_bf16 v[44:47], v[84:87], v[36:39], v[44:47]
    v_mfma_f32_16x16x32_bf16 v[48:51], v[88:91], v[36:39], v[48:51]
    v_mfma_f32_16x16x32_bf16 v[52:55], v[92:95], v[36:39], v[52:55]
    s_mov_b32 exec_lo, 0x30003
    s_mov_b32 exec_hi, 0x30003
    s_nop 2
    v_cvt_pk_bf16_f32 v40, v40, v41
    v_cvt_pk_bf16_f32 v41, v42, v43
    v_mov_b32 v42, s14
    v_cvt_pk_bf16_f32 v44, v44, v45
    v_cvt_pk_bf16_f32 v45, v46, v47
    v_mov_b32 v46, s14
    v_cvt_pk_bf16_f32 v48, v48, v49
    v_cvt_pk_bf16_f32 v49, v50, v51
    v_mov_b32 v50, s14
    v_cvt_pk_bf16_f32 v52, v52, v53
    v_cvt_pk_bf16_f32 v53, v54, v55
    v_mov_b32 v54, s14
    buffer_store_dwordx4 v[40:43], v5, s[40:43], s9 offen offset:0 sc1
    buffer_store_dwordx4 v[44:47], v5, s[40:43], s9 offen offset:1024 sc1
    buffer_store_dwordx4 v[48:51], v5, s[40:43], s9 offen offset:2048 sc1
    buffer_store_dwordx4 v[52:55], v5, s[40:43], s9 offen offset:3072 sc1
    s_mov_b64 exec, -1
    s_setprio 0
LGo:
    s_cmp_eq_u32 s3, 0
    s_cbranch_scc0 LGr
    v_mov_b32 v8, s14
    v_mov_b32 v9, s14
    v_mov_b32 v10, s14
    v_mov_b32 v11, s14
    v_mov_b32 v12, 0
    s_lshl_b32 s15, s2, 4
    s_add_u32 s15, s15, 4096
    s_mov_b64 exec, 1
    buffer_store_dwordx4 v[8:11], v12, s[40:43], s15 offen sc1
    s_mov_b64 exec, -1
    s_waitcnt vmcnt(0)
LGr:
    s_barrier
    s_add_u32 s58, s7, s52
    s_mov_b32 s59, s8
    s_mov_b32 m0, s58
    s_add_u32 s58, s58, 8192
LGx2:
    buffer_load_dwordx4 v2, s[44:47], s59 offen  lds
    s_add_u32 m0, m0, 1024
    s_add_u32 s59, s59, 57344
    s_cmp_lt_u32 m0, s58
    s_cbranch_scc1 LGx2
    s_xor_b32 s52, s52, 8192
    s_add_u32 s58, s7, s52
    s_mov_b32 s59, s8
    s_mov_b32 m0, s58
    s_add_u32 s58, s58, 8192
LGx3:
    buffer_load_dwordx4 v2, s[48:51], s59 offen  lds
    s_add_u32 m0, m0, 1024
    s_add_u32 s59, s59, 57344
    s_cmp_lt_u32 m0, s58
    s_cbranch_scc1 LGx3
    s_xor_b32 s52, s52, 8192
    s_mov_b64 s[48:49], s[16:17]
    s_mov_b32 s50, 2048
    v_lshrrev_b32 v4, 5, v0
    v_and_b32 v5, 31, v0
    v_lshlrev_b32 v19, 3, v5
    v_lshl_add_u32 v19, v4, 10, v19
    s_lshl_b32 s15, s3, 8
    buffer_load_dwordx2 v[24:25], v19, s[48:51], s15 offen
    s_lshl_b32 s9, s53, 15
    s_add_u32 s9, s9, s15
    v_lshlrev_b32 v229, 4, v0
    s_mov_b32 s27, 6144
    buffer_load_dword v237, v229, s[40:43], s27 offen sc1
    v_lshlrev_b32 v18, 1, v19
    s_lshl_b32 s15, s3, 9
    s_add_u32 s28, s15, 16384
    s_add_u32 s29, s15, 20480
    s_add_u32 s30, s15, 24576
    buffer_load_dwordx4 v[208:211], v18, s[40:43], s28 offen sc1
    buffer_load_dwordx4 v[212:215], v18, s[40:43], s29 offen sc1
    buffer_load_dwordx4 v[216:219], v18, s[40:43], s30 offen sc1
    s_add_u32 s16, s15, 131072
    s_add_u32 s17, s15, 135168
    s_add_u32 s18, s15, 139264
    s_add_u32 s19, s15, 143360
    s_add_u32 s20, s15, 147456
    s_add_u32 s21, s15, 151552
    s_add_u32 s22, s15, 155648
    s_add_u32 s23, s15, 159744
    v_lshrrev_b32 v8, 4, v0
    v_and_b32 v9, 15, v0
    v_lshlrev_b32 v6, 1, v8
    v_xor_b32 v6, v9, v6
    v_lshlrev_b32 v6, 4, v6
    v_lshl_add_u32 v6, v8, 10, v6
    v_xor_b32 v7, 0x80, v6
    s_mov_b64 s[44:45], s[32:33]
    s_mov_b32 s46, 1835008
    s_lshl_b32 s6, s3, 13
    s_add_u32 s6, s6, 81920
    s_mov_b32 m0, s6
    s_add_u32 s13, s6, 8192
LGd2:
    buffer_load_dwordx4 v6, s[44:47], s9 offen nt lds
    s_add_u32 m0, m0, 1024
    s_add_u32 s9, s9, 4096
    buffer_load_dwordx4 v7, s[44:47], s9 offen nt lds
    s_add_u32 m0, m0, 1024
    s_add_u32 s9, s9, 4096
    s_cmp_lt_u32 m0, s13
    s_cbranch_scc1 LGd2
    v_bfe_u32 v8, v0, 4, 1
    v_lshlrev_b32 v8, 5, v8
    v_lshl_add_u32 v8, v1, 6, v8
    v_lshl_add_u32 v8, v3, 3, v8
    v_add_u32 v8, s7, v8
    v_xor_b32 v9, 32, v8
    v_lshrrev_b32 v6, 2, v0
    v_and_b32 v10, 7, v6
    v_lshlrev_b32 v10, 5, v10
    v_lshl_add_u32 v10, v6, 8, v10
    v_and_b32 v7, 3, v0
    v_lshl_add_u32 v10, v7, 3, v10
    v_add_u32 v10, s6, v10
    v_xor_b32 v11, 32, v10
    v_xor_b32 v12, 64, v10
    v_xor_b32 v13, 96, v10
    v_xor_b32 v14, 128, v10
    v_xor_b32 v15, 160, v10
    v_xor_b32 v16, 192, v10
    v_xor_b32 v17, 224, v10
    v_mul_u32_u24 v20, 816, v4
    v_lshrrev_b32 v6, 3, v5
    v_lshl_add_u32 v20, v6, 6, v20
    v_lshl_add_u32 v20, v3, 4, v20
    v_bfe_u32 v6, v0, 2, 1
    v_lshl_add_u32 v20, v6, 3, v20
    s_add_u32 s15, s7, 4096
    v_add_u32 v20, s15, v20
    v_mul_u32_u24 v22, 816, v6
    v_and_b32 v7, 48, v0
    v_add3_u32 v22, v22, v7, s15
    v_min_u32 v21, 2, v3
    v_mul_u32_u24 v21, 272, v21
    v_add_u32 v22, v22, v21
    v_bfe_u32 v228, v0, 4, 1
    v_mul_u32_u24 v228, 7168, v228
    v_lshl_add_u32 v228, v4, 6, v228
    v_and_b32 v227, 15, v0
    v_lshl_add_u32 v228, v227, 2, v228
    v_lshlrev_b32 v2, 3, v0
    s_lshl_b32 s15, s3, 9
    v_add_u32 v23, s15, v2
    v_lshlrev_b32 v2, 8, v6
    v_and_b32 v227, 8, v0
    v_lshl_add_u32 v2, v227, 4, v2
    v_lshl_add_u32 v2, v7, 1, v2
    v_lshl_add_u32 v2, v3, 3, v2
    s_lshl_b32 s15, s3, 2
    v_add_u32 v226, s15, v7
    v_and_b32 v231, 16, v0
    v_lshlrev_b32 v231, 1, v231
    v_mov_b32 v232, 0x3727c5ac
    s_branch Lg4
LO3:
    s_movk_i32 s52, 1536
    s_lshr_b32 s58, s7, 2
    s_add_u32 s58, s58, 131072
    v_lshrrev_b32 v1, 4, v0
    v_lshlrev_b32 v18, 4, v0
    v_add_u32 v18, 147456, v18
    v_lshrrev_b32 v3, 3, v0
    v_and_b32 v2, 6, v3
    v_and_b32 v4, 7, v0
    v_xor_b32 v2, v2, v4
    v_mul_u32_u24 v3, 1024, v3
    v_lshl_add_u32 v2, v2, 4, v3
    s_lshl_b32 s53, s4, 19
    s_lshl_b32 s15, s3, 17
    s_add_u32 s53, s53, s15
    s_lshr_b32 s15, s52, 2
    s_add_u32 s53, s53, s15
    s_add_u32 s59, s7, 81920
    s_add_u32 s62, s7, 65536
    s_mov_b64 s[48:49], s[24:25]
    s_mov_b32 s50, 4194304
    s_branch LWm
LGH2:
    s_setprio 3
    s_mul_i32 s14, s14, 0x9E3779B1
    s_add_u32 s14, s14, 0x7F4A7C15
    s_mul_i32 s26, s4, 7
    s_add_u32 s26, s26, s5
    s_cmp_eq_u32 s5, 7
    s_cbranch_scc1 LGH3
    s_endpgm
LGH3:
    v_mov_b32 v8, s14
    v_mov_b32 v9, s14
    v_mov_b32 v10, s14
    v_mov_b32 v11, s14
    v_mov_b32 v12, 0
    s_lshl_b32 s15, s2, 4
    s_add_u32 s15, s15, 4096
    s_mov_b64 exec, 1
    buffer_store_dwordx4 v[8:11], v12, s[40:43], s15 offen sc1
    s_mov_b64 exec, -1
    s_endpgm
LWH2:
    s_setprio 3
    v_mov_b32 v32, -1
    v_mov_b32 v33, -1
    v_mov_b32 v34, -1
    v_mov_b32 v35, -1
    v_bfe_u32 v3, v0, 4, 1
    v_lshlrev_b32 v3, 11, v3
    v_and_b32 v4, 15, v0
    v_lshl_add_u32 v3, v4, 4, v3
    s_lshl_b32 s15, s4, 12
    s_and_b32 s6, s5, 7
    s_lshl_b32 s6, s6, 8
    s_add_u32 s15, s15, s6
    s_add_u32 s15, s15, 131072
    v_lshrrev_b32 v6, 4, v0
    v_lshlrev_b32 v6, 11, v6
    v_lshl_add_u32 v6, v4, 4, v6
    s_lshl_b32 s8, s6, 6
    s_lshl_b32 s9, s4, 8
    s_add_u32 s8, s8, s9
    s_add_u32 s8, s8, 1310720
    s_add_u32 s9, s8, 8192
    v_bfe_u32 v4, v0, 4, 1
    v_lshlrev_b32 v4, 10, v4
    v_and_b32 v11, 15, v0
    v_lshl_add_u32 v4, v11, 3, v4
    s_movk_i32 s6, 896
    s_mov_b32 s50, 2048
    s_waitcnt lgkmcnt(0)
    s_load_dword s14, s[40:41], 0
    s_mov_b64 s[48:49], s[34:35]
    buffer_load_dwordx2 v[28:29], v4, s[48:51], s6 offen
    buffer_store_dwordx4 v[32:35], v6, s[40:43], s8 offen sc1
    buffer_store_dwordx4 v[32:35], v6, s[40:43], s9 offen sc1
    s_mov_b32 exec_hi, 0
    buffer_store_dwordx4 v[32:35], v3, s[40:43], s15 offen sc1
    s_mov_b64 exec, -1
    v_bfe_u32 v10, v0, 4, 1
    v_mul_u32_u24 v5, 144, v10
    v_bfe_u32 v4, v0, 3, 1
    v_lshl_add_u32 v5, v4, 6, v5
    v_and_b32 v4, 3, v0
    v_lshl_add_u32 v5, v4, 4, v5
    v_bfe_u32 v4, v0, 2, 1
    v_lshl_add_u32 v5, v4, 3, v5
    v_add_u32 v5, 149504, v5
    s_waitcnt vmcnt(0) lgkmcnt(0)
    s_mul_i32 s14, s14, 0x9E3779B1
    s_add_u32 s14, s14, 0x7F4A7C15
    v_mov_b32 v8, s14
    v_mov_b32 v9, s14
    v_mov_b32 v10, s14
    v_mov_b32 v11, s14
    v_mov_b32 v12, 0
    s_lshl_b32 s15, s2, 4
    s_add_u32 s15, s15, 4096
    s_mov_b64 exec, 1
    buffer_store_dwordx4 v[8:11], v12, s[40:43], s15 offen sc1
    s_mov_b64 exec, -1
    v_lshlrev_b32 v2, 4, v0
    s_lshl_b32 s8, s4, 12
    s_add_u32 s8, s8, 32768
    v_and_b32 v3, 1, v0
    v_mul_u32_u24 v3, 144, v3
    v_bfe_u32 v4, v0, 1, 2
    v_lshl_add_u32 v3, v4, 4, v3
    v_lshrrev_b32 v4, 5, v0
    v_lshl_add_u32 v3, v4, 6, v3
    v_bfe_u32 v4, v0, 4, 1
    v_lshl_add_u32 v3, v4, 3, v3
    v_add_u32 v3, 150016, v3
    s_mov_b32 s96, s8
    s_add_u32 s97, s8, 32768
    s_mov_b32 s8, s97
    s_mov_b32 s12, 400007
    buffer_load_dwordx4 v[40:43], v2, s[40:43], s8 offen offset:0 sc1
    buffer_load_dwordx4 v[44:47], v2, s[40:43], s8 offen offset:1024 sc1
    buffer_load_dwordx4 v[48:51], v2, s[40:43], s8 offen offset:2048 sc1
    buffer_load_dwordx4 v[52:55], v2, s[40:43], s8 offen offset:3072 sc1
    v_lshlrev_b32 v16, 16, v28
    v_and_b32 v17, 0xffff0000, v28
    v_lshlrev_b32 v18, 16, v29
    v_and_b32 v19, 0xffff0000, v29
    v_mul_f32 v24, 0xbfb8aa3b, v16
    v_mul_f32 v25, 0xbfb8aa3b, v17
    v_mul_f32 v26, 0xbfb8aa3b, v18
    v_mul_f32 v27, 0xbfb8aa3b, v19
    v_exp_f32 v24, v24
    v_exp_f32 v25, v25
    v_exp_f32 v26, v26
    v_exp_f32 v27, v27
    v_add_f32 v24, 1.0, v24
    v_add_f32 v25, 1.0, v25
    v_add_f32 v26, 1.0, v26
    v_add_f32 v27, 1.0, v27
    v_rcp_f32 v24, v24
    v_rcp_f32 v25, v25
    v_rcp_f32 v26, v26
    v_rcp_f32 v27, v27
    v_mul_f32 v16, v16, v24
    v_mul_f32 v17, v17, v25
    v_mul_f32 v18, v18, v26
    v_mul_f32 v19, v19, v27
    v_cvt_pk_bf16_f32 v28, v16, v17
    v_cvt_pk_bf16_f32 v29, v18, v19
    ds_write_b64 v5, v[28:29]
    s_branch Lpe7
Lp5:
    buffer_load_dwordx4 v[40:43], v2, s[40:43], s8 offen offset:0 sc1
    buffer_load_dwordx4 v[44:47], v2, s[40:43], s8 offen offset:1024 sc1
    buffer_load_dwordx4 v[48:51], v2, s[40:43], s8 offen offset:2048 sc1
    buffer_load_dwordx4 v[52:55], v2, s[40:43], s8 offen offset:3072 sc1
Lpe7:
    s_waitcnt vmcnt(3)
    v_xor_b32 v43, s14, v42
    v_lshlrev_b32 v64, 16, v40
    v_and_b32 v65, 0xffff0000, v40
    v_lshlrev_b32 v66, 16, v41
    v_and_b32 v67, 0xffff0000, v41
    s_waitcnt vmcnt(2)
    v_xor_b32 v47, s14, v46
    v_lshlrev_b32 v68, 16, v44
    v_and_b32 v69, 0xffff0000, v44
    v_lshlrev_b32 v70, 16, v45
    v_and_b32 v71, 0xffff0000, v45
    s_waitcnt vmcnt(1)
    v_xor_b32 v51, s14, v50
    v_lshlrev_b32 v72, 16, v48
    v_and_b32 v73, 0xffff0000, v48
    v_lshlrev_b32 v74, 16, v49
    v_and_b32 v75, 0xffff0000, v49
    s_waitcnt vmcnt(0)
    v_xor_b32 v55, s14, v54
    v_lshlrev_b32 v76, 16, v52
    v_and_b32 v77, 0xffff0000, v52
    v_lshlrev_b32 v78, 16, v53
    v_and_b32 v79, 0xffff0000, v53
    v_or3_b32 v43, v43, v47, v51
    v_or_b32 v43, v43, v55
    v_cmp_ne_u32 s[10:11], 0, v43
    s_cmp_eq_u64 s[10:11], 0
    s_cbranch_scc1 Lpd6
    s_and_b32 s13, s12, 7
    s_cselect_b32 s8, s97, s96
    s_sub_u32 s12, s12, 1
    s_cbranch_scc0 Lp5
Lpd6:
    v_permlane32_swap_b32 v64, v72
    v_permlane32_swap_b32 v65, v73
    v_permlane32_swap_b32 v66, v74
    v_permlane32_swap_b32 v67, v75
    v_permlane32_swap_b32 v68, v76
    v_permlane32_swap_b32 v69, v77
    v_permlane32_swap_b32 v70, v78
    v_permlane32_swap_b32 v71, v79
    v_pk_add_f32 v[64:65], v[64:65], v[72:73]
    v_pk_add_f32 v[66:67], v[66:67], v[74:75]
    v_pk_add_f32 v[68:69], v[68:69], v[76:77]
    v_pk_add_f32 v[70:71], v[70:71], v[78:79]
    s_nop 0
    v_permlane16_swap_b32 v64, v68
    v_permlane16_swap_b32 v65, v69
    v_permlane16_swap_b32 v66, v70
    v_permlane16_swap_b32 v67, v71
    v_pk_add_f32 v[64:65], v[64:65], v[68:69]
    v_pk_add_f32 v[66:67], v[66:67], v[70:71]
    s_nop 0
    v_add_f32_dpp v64, v64, v64 row_ror:8 row_mask:0xf bank_mask:0xf
    v_add_f32_dpp v65, v65, v65 row_ror:8 row_mask:0xf bank_mask:0xf
    v_add_f32_dpp v66, v66, v66 row_ror:8 row_mask:0xf bank_mask:0xf
    v_add_f32_dpp v67, v67, v67 row_ror:8 row_mask:0xf bank_mask:0xf
    v_cvt_pk_bf16_f32 v40, v64, v65
    v_cvt_pk_bf16_f32 v41, v66, v67
    ds_write_b64 v3, v[40:41]
    s_waitcnt lgkmcnt(0)
    s_barrier
    s_endpgm
LTH:
    s_setprio 3
    v_mov_b32 v40, -1
    v_mov_b32 v41, -1
    v_mov_b32 v42, -1
    v_mov_b32 v43, -1
    v_lshlrev_b32 v2, 4, v0
    s_lshl_b32 s6, s4, 4
    s_add_u32 s6, s6, s5
    s_lshl_b32 s54, s6, 10
    s_add_u32 s54, s54, 180224
    s_lshl_b32 s55, s6, 7
    s_add_u32 s55, s55, 163840
    s_waitcnt lgkmcnt(0)
    s_load_dword s14, s[40:41], 0
    buffer_store_dwordx4 v[40:43], v2, s[40:43], s54 offen sc1
    s_add_u32 s54, s54, 147456
    buffer_store_dwordx4 v[40:43], v2, s[40:43], s54 offen sc1
    s_mov_b64 exec, 0xff
    buffer_store_dwordx4 v[40:43], v2, s[40:43], s55 offen sc1
    s_add_u32 s55, s55, 147456
    buffer_store_dwordx4 v[40:43], v2, s[40:43], s55 offen sc1
    s_mov_b64 exec, -1
    s_waitcnt vmcnt(0) lgkmcnt(0)
    s_mul_i32 s14, s14, 0x9E3779B1
    s_add_u32 s14, s14, 0x7F4A7C15
    v_mov_b32 v44, s14
    v_mov_b32 v45, s14
    v_mov_b32 v46, s14
    v_mov_b32 v47, s14
    v_mov_b32 v48, 0
    s_lshl_b32 s15, s6, 4
    s_add_u32 s15, s15, 4096
    s_mov_b64 exec, 1
    buffer_store_dwordx4 v[44:47], v48, s[40:43], s15 offen sc1
    s_mov_b64 exec, -1
    buffer_load_dwordx4 v[232:235], v2, s[40:43], s54 offen sc1
    s_mov_b64 exec, 1
    buffer_load_dword v236, v2, s[40:43], s55 offen sc1
    s_endpgm
.p2align 12, , 2100
Lg4:
    s_lshl_b32 s13, s4, 7
    s_add_u32 s13, s13, 9216
    s_lshl_b32 s15, s5, 2
    s_add_u32 s15, s15, s3
    s_cmp_eq_u32 s15, 3
    s_cselect_b32 s13, s13, 0x7ffffff0
    v_mov_b32 v235, s13
    v_mov_b32 v234, s14
    s_mov_b64 s[62:63], 1
    v_lshlrev_b32 v224, 7, v0
    v_add_u32 v224, 8192, v224
    s_waitcnt vmcnt(8)
    ds_read_b64_tr_b16 v[64:65], v8 offset:0
    ds_read_b64_tr_b16 v[66:67], v8 offset:1024
    ds_read_b64_tr_b16 v[68:69], v9 offset:0
    ds_read_b64_tr_b16 v[70:71], v9 offset:1024
    ds_read_b64_tr_b16 v[72:73], v8 offset:2048
    ds_read_b64_tr_b16 v[74:75], v8 offset:3072
    ds_read_b64_tr_b16 v[76:77], v9 offset:2048
    ds_read_b64_tr_b16 v[78:79], v9 offset:3072
    ds_read_b64_tr_b16 v[80:81], v8 offset:4096
    ds_read_b64_tr_b16 v[82:83], v8 offset:5120
    ds_read_b64_tr_b16 v[84:85], v9 offset:4096
    ds_read_b64_tr_b16 v[86:87], v9 offset:5120
    ds_read_b64_tr_b16 v[88:89], v8 offset:6144
    ds_read_b64_tr_b16 v[90:91], v8 offset:7168
    ds_read_b64_tr_b16 v[92:93], v9 offset:6144
    ds_read_b64_tr_b16 v[94:95], v9 offset:7168
    ds_read_b64_tr_b16 v[96:97], v8 offset:8192
    ds_read_b64_tr_b16 v[98:99], v8 offset:9216
    ds_read_b64_tr_b16 v[100:101], v9 offset:8192
    ds_read_b64_tr_b16 v[102:103], v9 offset:9216
    ds_read_b64_tr_b16 v[104:105], v8 offset:10240
    ds_read_b64_tr_b16 v[106:107], v8 offset:11264
    ds_read_b64_tr_b16 v[108:109], v9 offset:10240
    ds_read_b64_tr_b16 v[110:111], v9 offset:11264
    ds_read_b64_tr_b16 v[112:113], v8 offset:12288
    ds_read_b64_tr_b16 v[114:115], v8 offset:13312
    ds_read_b64_tr_b16 v[116:117], v9 offset:12288
    ds_read_b64_tr_b16 v[118:119], v9 offset:13312
    ds_read_b64_tr_b16 v[120:121], v8 offset:14336
    ds_read_b64_tr_b16 v[122:123], v8 offset:15360
    ds_read_b64_tr_b16 v[124:125], v9 offset:14336
    ds_read_b64_tr_b16 v[126:127], v9 offset:15360
    v_lshlrev_b32 v28, 16, v24
    v_and_b32 v29, 0xffff0000, v24
    v_lshlrev_b32 v30, 16, v25
    v_and_b32 v31, 0xffff0000, v25
    v_and_b32 v24, 32, v0
    v_add_u32 v24, 148480, v24
    ds_read_b128 v[32:35], v24
    v_cmp_ne_u32 vcc, s14, v237
    s_cbranch_vccz Lok8
    s_mov_b32 s12, 100000
Lp9:
    buffer_load_dword v237, v229, s[40:43], s27 offen sc1
    s_waitcnt vmcnt(0)
    v_cmp_ne_u32 s[10:11], s14, v237
    s_cmp_eq_u64 s[10:11], 0
    s_cbranch_scc1 Lpd10
    s_sleep 2
    s_sub_u32 s12, s12, 1
    s_cbranch_scc0 Lp9
Lpd10:
Lok8:
    v_xor_b32 v211, s14, v210
    v_xor_b32 v215, s14, v214
    v_xor_b32 v219, s14, v218
    v_or3_b32 v211, v211, v215, v219
    v_cmp_ne_u32 vcc, 0, v211
    s_cbranch_vccz LGmo
    s_mov_b32 s12, 100000
Lp11:
    buffer_load_dwordx4 v[208:211], v18, s[40:43], s28 offen sc1
    buffer_load_dwordx4 v[212:215], v18, s[40:43], s29 offen sc1
    buffer_load_dwordx4 v[216:219], v18, s[40:43], s30 offen sc1
    s_waitcnt vmcnt(2)
    v_cmp_ne_u32 s[10:11], s14, v210
    s_waitcnt vmcnt(1)
    v_cmp_ne_u32 vcc, s14, v214
    s_or_b64 s[10:11], s[10:11], vcc
    s_waitcnt vmcnt(0)
    v_cmp_ne_u32 vcc, s14, v218
    s_or_b64 s[10:11], s[10:11], vcc
    s_cmp_eq_u64 s[10:11], 0
    s_cbranch_scc1 Lpd12
    s_sleep 1
    s_sub_u32 s12, s12, 1
    s_cbranch_scc0 Lp11
Lpd12:
LGmo:
    s_mov_b32 s12, 100000
    buffer_load_dwordx4 v[160:163], v18, s[40:43], s16 offen sc1
    buffer_load_dwordx4 v[164:167], v18, s[40:43], s17 offen sc1
    buffer_load_dwordx4 v[168:171], v18, s[40:43], s18 offen sc1
    buffer_load_dwordx4 v[172:175], v18, s[40:43], s19 offen sc1
    buffer_load_dwordx4 v[176:179], v18, s[40:43], s20 offen sc1
    buffer_load_dwordx4 v[180:183], v18, s[40:43], s21 offen sc1
    buffer_load_dwordx4 v[184:187], v18, s[40:43], s22 offen sc1
    buffer_load_dwordx4 v[188:191], v18, s[40:43], s23 offen sc1
    s_waitcnt lgkmcnt(0)
    ds_write_b64 v20, v[212:213] offset:544
    v_pk_add_f32 v[32:33], v[32:33], v[34:35]
    v_add_f32 v32, v32, v33
    v_fmac_f32 v28, 0xbb000000, v32
    v_fmac_f32 v29, 0xbb000000, v32
    v_fmac_f32 v30, 0xbb000000, v32
    v_fmac_f32 v31, 0xbb000000, v32
    v_lshlrev_b32 v196, 16, v216
    v_and_b32 v197, 0xffff0000, v216
    v_lshlrev_b32 v198, 16, v217
    v_and_b32 v199, 0xffff0000, v217
    v_add_f32 v196, 1.0, v196
    v_add_f32 v197, 1.0, v197
    v_add_f32 v198, 1.0, v198
    v_add_f32 v199, 1.0, v199
    v_cvt_pk_bf16_f32 v36, v196, v197
    v_cvt_pk_bf16_f32 v37, v198, v199
    ds_write_b64 v20, v[36:37] offset:272
    v_lshlrev_b32 v192, 16, v208
    v_and_b32 v193, 0xffff0000, v208
    v_lshlrev_b32 v194, 16, v209
    v_and_b32 v195, 0xffff0000, v209
    v_lshlrev_b32 v196, 16, v36
    v_and_b32 v197, 0xffff0000, v36
    v_lshlrev_b32 v198, 16, v37
    v_and_b32 v199, 0xffff0000, v37
    v_mul_f32 v200, v28, v196
    v_mul_f32 v201, v29, v197
    v_mul_f32 v202, v30, v198
    v_mul_f32 v203, v31, v199
    v_mul_f32 v196, v192, v196
    v_mul_f32 v197, v193, v197
    v_mul_f32 v198, v194, v198
    v_mul_f32 v199, v195, v199
    s_waitcnt vmcnt(8)
    ds_read_b64_tr_b16 v[128:129], v10 offset:0
    ds_read_b64_tr_b16 v[130:131], v10 offset:4096
    ds_read_b64_tr_b16 v[132:133], v11 offset:0
    ds_read_b64_tr_b16 v[134:135], v11 offset:4096
    ds_read_b64_tr_b16 v[136:137], v12 offset:0
    ds_read_b64_tr_b16 v[138:139], v12 offset:4096
    ds_read_b64_tr_b16 v[140:141], v13 offset:0
    ds_read_b64_tr_b16 v[142:143], v13 offset:4096
    ds_read_b64_tr_b16 v[144:145], v14 offset:0
    ds_read_b64_tr_b16 v[146:147], v14 offset:4096
    ds_read_b64_tr_b16 v[148:149], v15 offset:0
    ds_read_b64_tr_b16 v[150:151], v15 offset:4096
    ds_read_b64_tr_b16 v[152:153], v16 offset:0
    ds_read_b64_tr_b16 v[154:155], v16 offset:4096
    ds_read_b64_tr_b16 v[156:157], v17 offset:0
    ds_read_b64_tr_b16 v[158:159], v17 offset:4096
    s_branch Lpe15
Lp13:
    buffer_load_dwordx4 v[160:163], v18, s[40:43], s16 offen sc1
    buffer_load_dwordx4 v[164:167], v18, s[40:43], s17 offen sc1
    buffer_load_dwordx4 v[168:171], v18, s[40:43], s18 offen sc1
    buffer_load_dwordx4 v[172:175], v18, s[40:43], s19 offen sc1
    buffer_load_dwordx4 v[176:179], v18, s[40:43], s20 offen sc1
    buffer_load_dwordx4 v[180:183], v18, s[40:43], s21 offen sc1
    buffer_load_dwordx4 v[184:187], v18, s[40:43], s22 offen sc1
    buffer_load_dwordx4 v[188:191], v18, s[40:43], s23 offen sc1
Lpe15:
    s_waitcnt vmcnt(6)
    v_pk_add_f32 v[56:57], v[160:161], v[164:165]
    v_pk_add_f32 v[58:59], v[162:163], v[166:167]
    s_waitcnt vmcnt(5)
    v_pk_add_f32 v[56:57], v[56:57], v[168:169]
    v_pk_add_f32 v[58:59], v[58:59], v[170:171]
    s_waitcnt vmcnt(4)
    v_pk_add_f32 v[56:57], v[56:57], v[172:173]
    v_pk_add_f32 v[58:59], v[58:59], v[174:175]
    s_waitcnt vmcnt(3)
    v_pk_add_f32 v[56:57], v[56:57], v[176:177]
    v_pk_add_f32 v[58:59], v[58:59], v[178:179]
    s_waitcnt vmcnt(2)
    v_pk_add_f32 v[56:57], v[56:57], v[180:181]
    v_pk_add_f32 v[58:59], v[58:59], v[182:183]
    s_waitcnt vmcnt(1)
    v_pk_add_f32 v[56:57], v[56:57], v[184:185]
    v_pk_add_f32 v[58:59], v[58:59], v[186:187]
    s_waitcnt vmcnt(0)
    v_pk_add_f32 v[56:57], v[56:57], v[188:189]
    v_pk_add_f32 v[58:59], v[58:59], v[190:191]
    v_cmp_u_f32 s[10:11], v56, v57
    v_cmp_u_f32 vcc, v58, v59
    s_or_b64 s[10:11], s[10:11], vcc
    s_cmp_eq_u64 s[10:11], 0
    s_cbranch_scc1 Lpd14
    s_sub_u32 s12, s12, 1
    s_cbranch_scc0 Lp13
Lpd14:
    v_pk_fma_f32 v[200:201], v[56:57], v[196:197], v[200:201]
    v_pk_fma_f32 v[202:203], v[58:59], v[198:199], v[202:203]
    v_cvt_pk_bf16_f32 v32, v200, v201
    v_cvt_pk_bf16_f32 v33, v202, v203
    ds_write_b64 v20, v[32:33]
    ds_read_b128 v[172:175], v22 offset:0
    ds_read_b128 v[176:179], v22 offset:64
    ds_read_b128 v[180:183], v22 offset:128
    ds_read_b128 v[184:187], v22 offset:192
    v_pk_fma_f32 v[28:29], v[56:57], v[192:193], v[28:29]
    v_pk_fma_f32 v[30:31], v[58:59], v[194:195], v[30:31]
    v_pk_add_f32 v[190:191], v[28:29], v[30:31]
    v_pk_mul_f32 v[28:29], v[28:29], v[28:29]
    v_pk_fma_f32 v[28:29], v[30:31], v[30:31], v[28:29]
    v_add_f32 v190, v190, v191
    v_add_f32 v191, v28, v29
    s_nop 1
    v_permlane16_swap_b32 v190, v191
    v_add_f32 v190, v190, v191
    s_nop 1
    v_add_f32_dpp v190, v190, v190 quad_perm:[1,0,3,2] row_mask:0xf bank_mask:0xf
    s_waitcnt lgkmcnt(3)
    v_mfma_f32_16x16x32_bf16 v[40:43], v[172:175], v[64:67], 0
    v_mfma_f32_16x16x32_bf16 v[44:47], v[172:175], v[68:71], 0
    v_add_f32_dpp v190, v190, v190 quad_perm:[2,3,0,1] row_mask:0xf bank_mask:0xf
    s_waitcnt lgkmcnt(2)
    v_mfma_f32_16x16x32_bf16 v[40:43], v[176:179], v[72:75], v[40:43]
    v_mfma_f32_16x16x32_bf16 v[44:47], v[176:179], v[76:79], v[44:47]
    v_add_f32_dpp v190, v190, v190 row_half_mirror row_mask:0xf bank_mask:0xf
    s_waitcnt lgkmcnt(1)
    v_mfma_f32_16x16x32_bf16 v[40:43], v[180:183], v[80:83], v[40:43]
    v_mfma_f32_16x16x32_bf16 v[44:47], v[180:183], v[84:87], v[44:47]
    v_add_f32_dpp v190, v190, v190 row_mirror row_mask:0xf bank_mask:0xf
    s_waitcnt lgkmcnt(0)
    ds_write_b32 v226, v190 offset:8192
    v_mfma_f32_16x16x32_bf16 v[40:43], v[184:187], v[88:91], v[40:43]
    v_mfma_f32_16x16x32_bf16 v[44:47], v[184:187], v[92:95], v[44:47]
    v_mfma_f32_16x16x32_bf16 v[48:51], v[172:175], v[96:99], 0
    v_mfma_f32_16x16x32_bf16 v[52:55], v[172:175], v[100:103], 0
    s_waitcnt lgkmcnt(0)
    s_barrier
    ds_read_b128 v[24:27], v231 offset:8192
    ds_read_b128 v[28:31], v231 offset:8208
    v_mfma_f32_16x16x32_bf16 v[48:51], v[176:179], v[104:107], v[48:51]
    v_mfma_f32_16x16x32_bf16 v[52:55], v[176:179], v[108:111], v[52:55]
    s_mov_b64 exec, s[62:63]
    buffer_store_dword v234, v235, s[40:43], 0 offen sc1
    s_mov_b64 exec, -1
    v_permlane32_swap_b32 v40, v44
    v_permlane32_swap_b32 v41, v45
    v_permlane32_swap_b32 v42, v46
    v_mfma_f32_16x16x32_bf16 v[48:51], v[180:183], v[112:115], v[48:51]
    v_mfma_f32_16x16x32_bf16 v[52:55], v[180:183], v[116:119], v[52:55]
    v_mfma_f32_16x16x32_bf16 v[48:51], v[184:187], v[120:123], v[48:51]
    v_mfma_f32_16x16x32_bf16 v[52:55], v[184:187], v[124:127], v[52:55]
    s_waitcnt lgkmcnt(0)
    v_pk_add_f32 v[24:25], v[24:25], v[26:27]
    v_pk_add_f32 v[28:29], v[28:29], v[30:31]
    v_add_f32 v24, v24, v25
    v_add_f32 v28, v28, v29
    v_mul_f32 v24, 0x3b000000, v24
    v_fmamk_f32 v28, v28, 0x3b000000, v232
    v_fma_f32 v28, -v24, v24, v28
    v_max_f32 v28, v28, v232
    v_rsq_f32 v28, v28
    v_permlane32_swap_b32 v48, v52
    v_permlane32_swap_b32 v49, v53
    v_permlane32_swap_b32 v50, v54
    v_fma_f32 v40, -v24, v41, v40
    v_fma_f32 v48, -v24, v49, v48
    v_fma_f32 v40, v40, v28, v42
    v_fma_f32 v41, v48, v28, v50
    ds_write_b64 v23, v[40:41] offset:0
    s_waitcnt lgkmcnt(0)
    s_barrier
    ds_read_b64 v[64:65], v2 offset:0
    ds_read_b64 v[66:67], v2 offset:512
    ds_read_b64 v[68:69], v2 offset:1024
    ds_read_b64 v[70:71], v2 offset:1536
    s_waitcnt lgkmcnt(2)
    v_pk_add_f32 v[64:65], v[64:65], v[66:67]
    s_waitcnt lgkmcnt(0)
    v_pk_add_f32 v[68:69], v[68:69], v[70:71]
    v_pk_add_f32 v[64:65], v[64:65], v[68:69]
    v_max_f32 v64, 0, v64
    v_mul_f32 v64, v64, v65
    s_nop 1
    v_mov_b32_dpp v65, v64 quad_perm:[1,0,3,2] row_mask:0xf bank_mask:0xf
    v_cvt_pk_bf16_f32 v24, v64, v65
    s_nop 1
    v_mov_b32_dpp v25, v24 row_shl:2 row_mask:0xf bank_mask:0xf
    v_mov_b32_dpp v26, v24 row_shl:4 row_mask:0xf bank_mask:0xf
    v_mov_b32_dpp v27, v24 row_shl:6 row_mask:0xf bank_mask:0xf
    s_nop 1
    v_mfma_f32_16x16x32_bf16 v[160:163], v[24:27], v[128:131], 0
    v_mfma_f32_16x16x32_bf16 v[164:167], v[24:27], v[132:135], 0
    v_mfma_f32_16x16x32_bf16 v[168:171], v[24:27], v[136:139], 0
    v_mfma_f32_16x16x32_bf16 v[172:175], v[24:27], v[140:143], 0
    v_mfma_f32_16x16x32_bf16 v[176:179], v[24:27], v[144:147], 0
    v_mfma_f32_16x16x32_bf16 v[180:183], v[24:27], v[148:151], 0
    v_mfma_f32_16x16x32_bf16 v[184:187], v[24:27], v[152:155], 0
    v_mfma_f32_16x16x32_bf16 v[188:191], v[24:27], v[156:159], 0
    s_nop 1
    v_permlane16_swap_b32 v160, v164
    buffer_store_dword v160, v228, s[40:43], s26 offen sc1
    s_add_u32 s26, s26, 14336
    v_permlane16_swap_b32 v168, v172
    buffer_store_dword v168, v228, s[40:43], s26 offen sc1
    s_add_u32 s26, s26, 14336
    v_permlane16_swap_b32 v176, v180
    buffer_store_dword v176, v228, s[40:43], s26 offen sc1
    s_add_u32 s26, s26, 14336
    v_permlane16_swap_b32 v184, v188
    buffer_store_dword v184, v228, s[40:43], s26 offen sc1
    s_endpgm
LM:
    s_mov_b32 s61, 7
    s_mul_i32 s9, s61, 393216
    s_lshl_b32 s15, s60, 9
    s_add_u32 s9, s9, s15
    s_lshl_b32 s15, s3, 7
    s_add_u32 s9, s9, s15
    s_add_u32 s9, s9, 2048
    s_mov_b32 m0, s63
    s_add_u32 s15, s63, 8192
Lmr16:
    buffer_load_dwordx4 v17, s[44:47], s9 offen nt lds
    s_add_u32 m0, m0, 1024
    s_add_u32 s9, s9, 49152
    s_cmp_lt_u32 m0, s15
    s_cbranch_scc1 Lmr16
    v_bfe_u32 v5, v0, 2, 3
    v_bfe_u32 v8, v0, 3, 2
    v_lshlrev_b32 v8, 5, v8
    v_lshl_add_u32 v8, v5, 7, v8
    v_lshrrev_b32 v5, 5, v0
    v_lshl_add_u32 v8, v5, 10, v8
    v_and_b32 v6, 3, v0
    v_lshl_add_u32 v8, v6, 3, v8
    v_add_u32 v8, s63, v8
    v_xor_b32 v9, 32, v8
    v_xor_b32 v10, 64, v8
    v_xor_b32 v11, 96, v8
    v_and_b32 v5, 1, v0
    v_and_b32 v6, 48, v0
    v_mul_u32_u24 v7, 144, v5
    v_add_u32 v7, v7, v6
    v_add_u32 v7, 149504, v7
    v_lshlrev_b32 v5, 4, v5
    v_lshl_add_u32 v5, v6, 1, v5
    ds_read_b128 v[32:35], v7 offset:0
    ds_read_b128 v[36:39], v7 offset:64
    s_lshl_b32 s9, s60, 14
    s_lshl_b32 s15, s3, 12
    s_add_u32 s9, s9, s15
    s_lshl_b32 s15, s61, 7
    s_add_u32 s9, s9, s15
    s_add_u32 s9, s9, 851968
    s_waitcnt vmcnt(0)
    s_setprio 3
    ds_read_b64_tr_b16 v[64:65], v8 offset:0
    ds_read_b64_tr_b16 v[66:67], v8 offset:2048
    ds_read_b64_tr_b16 v[68:69], v9 offset:0
    ds_read_b64_tr_b16 v[70:71], v9 offset:2048
    ds_read_b64_tr_b16 v[72:73], v10 offset:0
    ds_read_b64_tr_b16 v[74:75], v10 offset:2048
    ds_read_b64_tr_b16 v[76:77], v11 offset:0
    ds_read_b64_tr_b16 v[78:79], v11 offset:2048
    ds_read_b64_tr_b16 v[80:81], v8 offset:4096
    ds_read_b64_tr_b16 v[82:83], v8 offset:6144
    ds_read_b64_tr_b16 v[84:85], v9 offset:4096
    ds_read_b64_tr_b16 v[86:87], v9 offset:6144
    ds_read_b64_tr_b16 v[88:89], v10 offset:4096
    ds_read_b64_tr_b16 v[90:91], v10 offset:6144
    ds_read_b64_tr_b16 v[92:93], v11 offset:4096
    ds_read_b64_tr_b16 v[94:95], v11 offset:6144
    s_waitcnt lgkmcnt(0)
    v_mfma_f32_16x16x32_bf16 v[40:43], v[64:67], v[32:35], 0
    v_mfma_f32_16x16x32_bf16 v[44:47], v[68:71], v[32:35], 0
    v_mfma_f32_16x16x32_bf16 v[48:51], v[72:75], v[32:35], 0
    v_mfma_f32_16x16x32_bf16 v[52:55], v[76:79], v[32:35], 0
    v_mfma_f32_16x16x32_bf16 v[40:43], v[80:83], v[36:39], v[40:43]
    v_mfma_f32_16x16x32_bf16 v[44:47], v[84:87], v[36:39], v[44:47]
    v_mfma_f32_16x16x32_bf16 v[48:51], v[88:91], v[36:39], v[48:51]
    v_mfma_f32_16x16x32_bf16 v[52:55], v[92:95], v[36:39], v[52:55]
    s_mov_b32 exec_lo, 0x30003
    s_mov_b32 exec_hi, 0x30003
    s_nop 2
    v_cvt_pk_bf16_f32 v40, v40, v41
    v_cvt_pk_bf16_f32 v41, v42, v43
    v_mov_b32 v42, s14
    v_cvt_pk_bf16_f32 v44, v44, v45
    v_cvt_pk_bf16_f32 v45, v46, v47
    v_mov_b32 v46, s14
    v_cvt_pk_bf16_f32 v48, v48, v49
    v_cvt_pk_bf16_f32 v49, v50, v51
    v_mov_b32 v50, s14
    v_cvt_pk_bf16_f32 v52, v52, v53
    v_cvt_pk_bf16_f32 v53, v54, v55
    v_mov_b32 v54, s14
    buffer_store_dwordx4 v[40:43], v5, s[40:43], s9 offen offset:0 sc1
    buffer_store_dwordx4 v[44:47], v5, s[40:43], s9 offen offset:1024 sc1
    buffer_store_dwordx4 v[48:51], v5, s[40:43], s9 offen offset:2048 sc1
    buffer_store_dwordx4 v[52:55], v5, s[40:43], s9 offen offset:3072 sc1
    s_mov_b64 exec, -1
    s_setprio 0
LMr:
    s_lshl_b32 s6, s4, 2
    s_add_u32 s6, s6, s3
    s_lshl_b32 s8, s6, 12
    s_add_u32 s8, s8, 851968
    s_lshr_b32 s9, s6, 3
    s_lshl_b32 s9, s9, 12
    s_and_b32 s6, s6, 7
    s_lshl_b32 s6, s6, 8
    s_add_u32 s9, s9, s6
    s_add_u32 s9, s9, 16384
    v_lshlrev_b32 v2, 4, v0
    v_and_b32 v3, 1, v0
    v_lshlrev_b32 v3, 11, v3
    v_bfe_u32 v4, v0, 1, 2
    v_lshl_add_u32 v3, v4, 4, v3
    v_and_b32 v4, 48, v0
    v_lshl_add_u32 v3, v4, 2, v3
    s_mov_b32 s12, 100000
Lp17:
    buffer_load_dwordx4 v[40:43], v2, s[40:43], s8 offen offset:0 sc1
    buffer_load_dwordx4 v[44:47], v2, s[40:43], s8 offen offset:1024 sc1
    buffer_load_dwordx4 v[48:51], v2, s[40:43], s8 offen offset:2048 sc1
    buffer_load_dwordx4 v[52:55], v2, s[40:43], s8 offen offset:3072 sc1
    s_waitcnt vmcnt(3)
    v_cmp_ne_u32 s[10:11], s14, v42
    v_lshlrev_b32 v64, 16, v40
    v_and_b32 v65, 0xffff0000, v40
    v_lshlrev_b32 v66, 16, v41
    v_and_b32 v67, 0xffff0000, v41
    s_waitcnt vmcnt(2)
    v_cmp_ne_u32 vcc, s14, v46
    s_or_b64 s[10:11], s[10:11], vcc
    v_lshlrev_b32 v68, 16, v44
    v_and_b32 v69, 0xffff0000, v44
    v_lshlrev_b32 v70, 16, v45
    v_and_b32 v71, 0xffff0000, v45
    s_waitcnt vmcnt(1)
    v_cmp_ne_u32 vcc, s14, v50
    s_or_b64 s[10:11], s[10:11], vcc
    v_lshlrev_b32 v72, 16, v48
    v_and_b32 v73, 0xffff0000, v48
    v_lshlrev_b32 v74, 16, v49
    v_and_b32 v75, 0xffff0000, v49
    s_waitcnt vmcnt(0)
    v_cmp_ne_u32 vcc, s14, v54
    s_or_b64 s[10:11], s[10:11], vcc
    v_lshlrev_b32 v76, 16, v52
    v_and_b32 v77, 0xffff0000, v52
    v_lshlrev_b32 v78, 16, v53
    v_and_b32 v79, 0xffff0000, v53
    s_cmp_eq_u64 s[10:11], 0
    s_cbranch_scc1 Lpd18
    s_sleep 1
    s_sub_u32 s12, s12, 1
    s_cbranch_scc0 Lp17
Lpd18:
    v_permlane32_swap_b32 v64, v72
    v_permlane32_swap_b32 v65, v73
    v_permlane32_swap_b32 v66, v74
    v_permlane32_swap_b32 v67, v75
    v_permlane32_swap_b32 v68, v76
    v_permlane32_swap_b32 v69, v77
    v_permlane32_swap_b32 v70, v78
    v_permlane32_swap_b32 v71, v79
    v_pk_add_f32 v[64:65], v[64:65], v[72:73]
    v_pk_add_f32 v[66:67], v[66:67], v[74:75]
    v_pk_add_f32 v[68:69], v[68:69], v[76:77]
    v_pk_add_f32 v[70:71], v[70:71], v[78:79]
    s_nop 0
    v_permlane16_swap_b32 v64, v68
    v_permlane16_swap_b32 v65, v69
    v_permlane16_swap_b32 v66, v70
    v_permlane16_swap_b32 v67, v71
    v_pk_add_f32 v[64:65], v[64:65], v[68:69]
    v_pk_add_f32 v[66:67], v[66:67], v[70:71]
    s_nop 0
    v_add_f32_dpp v64, v64, v64 row_ror:8 row_mask:0xf bank_mask:0xf
    v_add_f32_dpp v65, v65, v65 row_ror:8 row_mask:0xf bank_mask:0xf
    v_add_f32_dpp v66, v66, v66 row_ror:8 row_mask:0xf bank_mask:0xf
    v_add_f32_dpp v67, v67, v67 row_ror:8 row_mask:0xf bank_mask:0xf
    v_cvt_pk_bf16_f32 v40, v64, v65
    v_cvt_pk_bf16_f32 v41, v66, v67
    s_mov_b32 exec_lo, 0xff00ff
    s_mov_b32 exec_hi, 0xff00ff
    buffer_store_dwordx4 v[40:43], v3, s[40:43], s9 offen sc1
    s_endpgm
.p2align 12, , 3300
Lg19:
LWHp:
    s_branch LWH2
LW2:
    v_lshrrev_b32 v3, 3, v0
    v_and_b32 v12, 6, v3
    v_and_b32 v4, 7, v0
    v_xor_b32 v12, v12, v4
    v_mul_u32_u24 v3, 6144, v3
    v_lshl_add_u32 v12, v12, 4, v3
    s_mov_b64 s[44:45], s[36:37]
    s_mov_b32 s46, 3145728
    s_mov_b32 s60, s4
    s_mov_b32 s61, s52
    s_add_u32 s63, s7, 73728
    v_mov_b32 v17, v12
    v_lshrrev_b32 v3, 2, v0
    v_and_b32 v8, 7, v3
    v_lshlrev_b32 v8, 5, v8
    v_lshl_add_u32 v8, v3, 8, v8
    v_and_b32 v5, 3, v0
    v_lshl_add_u32 v8, v5, 3, v8
    v_add_u32 v8, s7, v8
    v_xor_b32 v9, 32, v8
    v_xor_b32 v10, 64, v8
    v_xor_b32 v11, 96, v8
    v_xor_b32 v12, 128, v8
    v_xor_b32 v13, 160, v8
    v_xor_b32 v14, 192, v8
    v_xor_b32 v15, 224, v8
    s_lshr_b32 s58, s7, 2
    s_add_u32 s58, s58, 131072
    v_bfe_u32 v3, v0, 2, 1
    v_mul_u32_u24 v16, 144, v3
    v_lshl_add_u32 v16, v1, 4, v16
    v_add_u32 v16, 150016, v16
    v_lshlrev_b32 v18, 4, v0
    v_add_u32 v18, 147456, v18
    v_and_b32 v19, 15, v0
    v_lshlrev_b32 v19, 3, v19
    v_lshrrev_b32 v3, 5, v0
    v_lshl_add_u32 v19, v3, 7, v19
    v_and_b32 v3, 16, v0
    v_lshl_add_u32 v19, v3, 9, v19
    s_lshl_b32 s55, s52, 14
    s_lshl_b32 s15, s3, 11
    s_add_u32 s55, s55, s15
    s_lshl_b32 s15, s4, 8
    s_add_u32 s55, s55, s15
    s_add_u32 s55, s55, 1310720
    s_lshl_b32 s52, s52, 9
    v_lshrrev_b32 v3, 3, v0
    v_and_b32 v2, 6, v3
    v_and_b32 v4, 7, v0
    v_xor_b32 v2, v2, v4
    v_mul_u32_u24 v3, 1024, v3
    v_lshl_add_u32 v2, v2, 4, v3
    s_lshl_b32 s53, s4, 19
    s_lshl_b32 s15, s3, 17
    s_add_u32 s53, s53, s15
    s_lshr_b32 s15, s52, 2
    s_add_u32 s53, s53, s15
    s_add_u32 s59, s7, 81920
    s_add_u32 s62, s7, 65536
    s_mov_b64 s[48:49], s[24:25]
    s_mov_b32 s50, 4194304
    s_mov_b64 s[92:93], s[20:21]
    s_mov_b32 s94, 33554432
    s_mov_b32 s95, 0x20000
    s_lshl_b32 s8, s61, 2
    s_add_u32 s8, s8, s3
    s_lshr_b32 s9, s8, 4
    s_lshl_b32 s9, s9, 3
    s_add_u32 s9, s9, s4
    s_lshl_b32 s9, s9, 21
    s_and_b32 s8, s8, 15
    s_lshl_b32 s8, s8, 15
    s_add_u32 s8, s8, s9
    s_add_u32 s8, s8, 1585152
    v_lshrrev_b32 v20, 5, v0
    v_and_b32 v4, 31, v0
    v_lshlrev_b32 v4, 7, v4
    v_lshl_add_u32 v20, v20, 14, v4
    s_waitcnt vmcnt(8) lgkmcnt(0)
    s_mul_i32 s14, s14, 0x9E3779B1
    s_add_u32 s14, s14, 0x7F4A7C15
    ds_read_b64_tr_b16 v[64:65], v8 offset:0
    ds_read_b64_tr_b16 v[66:67], v8 offset:4096
    ds_read_b64_tr_b16 v[68:69], v9 offset:0
    ds_read_b64_tr_b16 v[70:71], v9 offset:4096
    ds_read_b64_tr_b16 v[72:73], v10 offset:0
    ds_read_b64_tr_b16 v[74:75], v10 offset:4096
    ds_read_b64_tr_b16 v[76:77], v11 offset:0
    ds_read_b64_tr_b16 v[78:79], v11 offset:4096
    ds_read_b64_tr_b16 v[80:81], v12 offset:0
    ds_read_b64_tr_b16 v[82:83], v12 offset:4096
    ds_read_b64_tr_b16 v[84:85], v13 offset:0
    ds_read_b64_tr_b16 v[86:87], v13 offset:4096
    ds_read_b64_tr_b16 v[88:89], v14 offset:0
    ds_read_b64_tr_b16 v[90:91], v14 offset:4096
    ds_read_b64_tr_b16 v[92:93], v15 offset:0
    ds_read_b64_tr_b16 v[94:95], v15 offset:4096
    s_waitcnt vmcnt(0)
    ds_read_b64_tr_b16 v[96:97], v8 offset:8192
    ds_read_b64_tr_b16 v[98:99], v8 offset:12288
    ds_read_b64_tr_b16 v[100:101], v9 offset:8192
    ds_read_b64_tr_b16 v[102:103], v9 offset:12288
    ds_read_b64_tr_b16 v[104:105], v10 offset:8192
    ds_read_b64_tr_b16 v[106:107], v10 offset:12288
    ds_read_b64_tr_b16 v[108:109], v11 offset:8192
    ds_read_b64_tr_b16 v[110:111], v11 offset:12288
    ds_read_b64_tr_b16 v[112:113], v12 offset:8192
    ds_read_b64_tr_b16 v[114:115], v12 offset:12288
    ds_read_b64_tr_b16 v[116:117], v13 offset:8192
    ds_read_b64_tr_b16 v[118:119], v13 offset:12288
    ds_read_b64_tr_b16 v[120:121], v14 offset:8192
    ds_read_b64_tr_b16 v[122:123], v14 offset:12288
    ds_read_b64_tr_b16 v[124:125], v15 offset:8192
    ds_read_b64_tr_b16 v[126:127], v15 offset:12288
    s_barrier
    ds_read_b128 v[24:27], v16 offset:0
    ds_read_b128 v[28:31], v16 offset:64
    s_waitcnt lgkmcnt(0)
    v_mfma_f32_16x16x32_bf16 v[128:131], v[24:27], v[64:67], 0
    v_mfma_f32_16x16x32_bf16 v[132:135], v[24:27], v[68:71], 0
    v_mfma_f32_16x16x32_bf16 v[136:139], v[24:27], v[72:75], 0
    v_mfma_f32_16x16x32_bf16 v[140:143], v[24:27], v[76:79], 0
    v_mfma_f32_16x16x32_bf16 v[144:147], v[24:27], v[80:83], 0
    v_mfma_f32_16x16x32_bf16 v[148:151], v[24:27], v[84:87], 0
    v_mfma_f32_16x16x32_bf16 v[152:155], v[24:27], v[88:91], 0
    v_mfma_f32_16x16x32_bf16 v[156:159], v[24:27], v[92:95], 0
    v_mfma_f32_16x16x32_bf16 v[128:131], v[28:31], v[96:99], v[128:131]
    v_mfma_f32_16x16x32_bf16 v[132:135], v[28:31], v[100:103], v[132:135]
    v_mfma_f32_16x16x32_bf16 v[136:139], v[28:31], v[104:107], v[136:139]
    v_mfma_f32_16x16x32_bf16 v[140:143], v[28:31], v[108:111], v[140:143]
    v_mfma_f32_16x16x32_bf16 v[144:147], v[28:31], v[112:115], v[144:147]
    v_mfma_f32_16x16x32_bf16 v[148:151], v[28:31], v[116:119], v[148:151]
    v_mfma_f32_16x16x32_bf16 v[152:155], v[28:31], v[120:123], v[152:155]
    v_mfma_f32_16x16x32_bf16 v[156:159], v[28:31], v[124:127], v[156:159]
    s_nop 1
    v_permlane32_swap_b32 v128, v132
    s_nop 0
    v_permlane32_swap_b32 v136, v140
    s_nop 0
    v_permlane32_swap_b32 v144, v148
    s_nop 0
    v_permlane32_swap_b32 v152, v156
    v_cvt_pk_bf16_f32 v56, v128, v136
    v_cvt_pk_bf16_f32 v57, v144, v152
    buffer_store_dwordx2 v[56:57], v19, s[40:43], s55 offen sc1
    s_barrier
    s_mov_b32 exec_lo, 0xffff0000
    s_mov_b32 exec_hi, 0xffff0000
    buffer_load_dword v236, v20, s[92:95], s8 offen
    s_mov_b64 exec, -1
    s_cmp_eq_u32 s61, 3
    s_cbranch_scc1 LM
LWm:
    s_mov_b32 m0, s62
    s_mov_b32 s62, s59
LWd20:
    buffer_load_dwordx4 v2, s[48:51], s53 offen nt lds
    s_add_u32 m0, m0, 1024
    s_add_u32 s53, s53, 8192
    s_cmp_lt_u32 m0, s62
    s_cbranch_scc1 LWd20
    v_and_b32 v3, 15, v0
    v_lshlrev_b32 v13, 7, v3
    s_lshl_b32 s9, s4, 14
    s_add_u32 s9, s9, 180224
    s_lshl_b32 s8, s4, 11
    s_add_u32 s8, s8, 163840
    v_lshlrev_b32 v229, 4, v0
    s_mul_i32 s13, s4, 240
    s_sub_u32 s13, 2432, s13
    v_mov_b32 v4, s13
    v_cmp_gt_u32 vcc, 16, v0
    s_nop 1
    v_cndmask_b32 v229, v4, v229, vcc
    s_lshl_b32 s27, s4, 8
    s_add_u32 s27, s27, 4096
    buffer_load_dword v237, v229, s[40:43], s27 offen sc1
    s_lshl_b32 s15, s3, 8
    s_add_u32 s9, s9, s15
    s_lshl_b32 s15, s3, 3
    s_add_u32 s8, s8, s15
    s_add_u32 s15, s7, 65536
    v_bfe_u32 v3, v0, 2, 3
    v_bfe_u32 v8, v0, 3, 2
    v_lshlrev_b32 v8, 5, v8
    v_lshl_add_u32 v8, v3, 7, v8
    v_lshrrev_b32 v3, 5, v0
    v_lshl_add_u32 v8, v3, 10, v8
    v_and_b32 v4, 3, v0
    v_lshl_add_u32 v8, v4, 3, v8
    v_add_u32 v8, s15, v8
    v_xor_b32 v9, 32, v8
    v_xor_b32 v10, 64, v8
    v_xor_b32 v11, 96, v8
    v_and_b32 v3, 15, v0
    v_xor_b32 v12, v3, v1
    v_lshlrev_b32 v12, 4, v12
    v_lshl_add_u32 v4, v1, 10, v12
    v_xor_b32 v5, 64, v4
    v_add_u32 v5, 3072, v5
    v_xor_b32 v6, 128, v4
    v_add_u32 v6, 6144, v6
    v_xor_b32 v7, 192, v4
    v_add_u32 v7, 9216, v7
    v_lshl_add_u32 v20, v3, 8, v12
    v_add_u32 v20, s58, v20
    v_xor_b32 v21, 64, v20
    v_xor_b32 v22, 128, v20
    v_xor_b32 v23, 192, v20
    v_lshlrev_b32 v14, 4, v1
    v_lshrrev_b32 v12, 5, v0
    v_lshlrev_b32 v15, 8, v12
    v_and_b32 v12, 31, v0
    v_lshl_add_u32 v15, v12, 2, v15
    s_lshl_b32 s15, s3, 9
    s_add_u32 s15, s15, 147456
    v_add_u32 v15, s15, v15
    v_lshlrev_b32 v17, 4, v3
    v_lshl_add_u32 v17, v1, 11, v17
    s_lshl_b32 s55, s4, 12
    s_lshr_b32 s15, s52, 1
    s_add_u32 s55, s55, s15
    s_add_u32 s55, s55, 131072
    s_mov_b32 m0, s58
    v_mov_b32 v128, 0
    s_waitcnt vmcnt(0)
    v_cmp_ne_u32 vcc, s14, v237
    s_cbranch_vccz Lok21
    s_mov_b32 s12, 100000
Lp22:
    buffer_load_dword v237, v229, s[40:43], s27 offen sc1
    s_waitcnt vmcnt(0)
    v_cmp_ne_u32 s[10:11], s14, v237
    s_cmp_eq_u64 s[10:11], 0
    s_cbranch_scc1 Lpd23
    s_sleep 2
    s_sub_u32 s12, s12, 1
    s_cbranch_scc0 Lp22
Lpd23:
Lok21:
    s_mov_b32 s96, s8
    s_add_u32 s97, s8, 147456
    s_mov_b32 s8, s97
    s_mov_b32 s98, s9
    s_add_u32 s99, s9, 147456
    s_mov_b32 s9, s99
    s_mov_b32 s12, 400031
    s_mov_b64 exec, 0xffff
    buffer_load_dwordx2 v[128:129], v13, s[40:43], s8 offen sc1
    s_mov_b64 exec, -1
    buffer_load_dwordx4 v4, s[40:43], s9 offen offset:0 sc1 lds
    buffer_load_dwordx4 v5, s[40:43], s9 offen offset:1024 sc1 lds
    buffer_load_dwordx4 v6, s[40:43], s9 offen offset:2048 sc1 lds
    buffer_load_dwordx4 v7, s[40:43], s9 offen offset:3072 sc1 lds
    ds_read_b64_tr_b16 v[64:65], v8 offset:0
    ds_read_b64_tr_b16 v[66:67], v8 offset:2048
    ds_read_b64_tr_b16 v[68:69], v9 offset:0
    ds_read_b64_tr_b16 v[70:71], v9 offset:2048
    ds_read_b64_tr_b16 v[72:73], v10 offset:0
    ds_read_b64_tr_b16 v[74:75], v10 offset:2048
    ds_read_b64_tr_b16 v[76:77], v11 offset:0
    ds_read_b64_tr_b16 v[78:79], v11 offset:2048
    ds_read_b64_tr_b16 v[80:81], v8 offset:4096
    ds_read_b64_tr_b16 v[82:83], v8 offset:6144
    ds_read_b64_tr_b16 v[84:85], v9 offset:4096
    ds_read_b64_tr_b16 v[86:87], v9 offset:6144
    ds_read_b64_tr_b16 v[88:89], v10 offset:4096
    ds_read_b64_tr_b16 v[90:91], v10 offset:6144
    ds_read_b64_tr_b16 v[92:93], v11 offset:4096
    ds_read_b64_tr_b16 v[94:95], v11 offset:6144
    ds_read_b64_tr_b16 v[96:97], v8 offset:8192
    ds_read_b64_tr_b16 v[98:99], v8 offset:10240
    ds_read_b64_tr_b16 v[100:101], v9 offset:8192
    ds_read_b64_tr_b16 v[102:103], v9 offset:10240
    ds_read_b64_tr_b16 v[104:105], v10 offset:8192
    ds_read_b64_tr_b16 v[106:107], v10 offset:10240
    ds_read_b64_tr_b16 v[108:109], v11 offset:8192
    ds_read_b64_tr_b16 v[110:111], v11 offset:10240
    ds_read_b64_tr_b16 v[112:113], v8 offset:12288
    ds_read_b64_tr_b16 v[114:115], v8 offset:14336
    ds_read_b64_tr_b16 v[116:117], v9 offset:12288
    ds_read_b64_tr_b16 v[118:119], v9 offset:14336
    ds_read_b64_tr_b16 v[120:121], v10 offset:12288
    ds_read_b64_tr_b16 v[122:123], v10 offset:14336
    ds_read_b64_tr_b16 v[124:125], v11 offset:12288
    ds_read_b64_tr_b16 v[126:127], v11 offset:14336
    s_waitcnt vmcnt(4)
    v_cmp_eq_u32 vcc, -1, v128
    s_cbranch_vccz LWc
    s_branch Lpe26
Lp24:
    s_mov_b64 exec, 0xffff
    buffer_load_dwordx2 v[128:129], v13, s[40:43], s8 offen sc1
    s_mov_b64 exec, -1
Lpe26:
    s_waitcnt vmcnt(0)
    v_cmp_eq_u32 s[10:11], -1, v128
    s_cmp_eq_u64 s[10:11], 0
    s_cbranch_scc1 Lpd25
    s_and_b32 s13, s12, 31
    s_cselect_b32 s8, s97, s96
    s_cselect_b32 s9, s99, s98
    s_sub_u32 s12, s12, 1
    s_cbranch_scc0 Lp24
Lpd25:
    s_mov_b32 s99, s9
    s_mov_b32 s12, 100007
    buffer_load_dwordx4 v4, s[40:43], s9 offen offset:0 sc1 lds
    buffer_load_dwordx4 v5, s[40:43], s9 offen offset:1024 sc1 lds
    buffer_load_dwordx4 v6, s[40:43], s9 offen offset:2048 sc1 lds
    buffer_load_dwordx4 v7, s[40:43], s9 offen offset:3072 sc1 lds
LWc:
    v_min_f32_dpp v134, v128, v128 quad_perm:[1,0,3,2] row_mask:0xf bank_mask:0xf
    s_nop 1
    v_min_f32_dpp v134, v134, v134 quad_perm:[2,3,0,1] row_mask:0xf bank_mask:0xf
    s_nop 1
    v_min_f32_dpp v134, v134, v134 row_half_mirror row_mask:0xf bank_mask:0xf
    v_sub_f32 v134, v134, v128
    v_exp_f32 v134, v134
    s_nop 0
    v_mul_f32 v135, v134, v129
    s_nop 1
    v_add_f32_dpp v135, v135, v135 quad_perm:[1,0,3,2] row_mask:0xf bank_mask:0xf
    s_nop 1
    v_add_f32_dpp v135, v135, v135 quad_perm:[2,3,0,1] row_mask:0xf bank_mask:0xf
    s_nop 1
    v_add_f32_dpp v135, v135, v135 row_half_mirror row_mask:0xf bank_mask:0xf
    v_rcp_f32 v135, v135
    s_nop 0
    v_mul_f32 v134, v134, v135
    ds_bpermute_b32 v130, v14, v134 offset:0
    ds_bpermute_b32 v131, v14, v134 offset:4
    ds_bpermute_b32 v132, v14, v134 offset:8
    ds_bpermute_b32 v133, v14, v134 offset:12
    s_branch Lpe29
Lp27:
    buffer_load_dwordx4 v4, s[40:43], s9 offen offset:0 sc1 lds
    buffer_load_dwordx4 v5, s[40:43], s9 offen offset:1024 sc1 lds
    buffer_load_dwordx4 v6, s[40:43], s9 offen offset:2048 sc1 lds
    buffer_load_dwordx4 v7, s[40:43], s9 offen offset:3072 sc1 lds
Lpe29:
    s_waitcnt vmcnt(0)
    ds_read_b128 v[24:27], v20
    ds_read_b128 v[28:31], v21
    ds_read_b128 v[32:35], v22
    ds_read_b128 v[36:39], v23
    s_waitcnt lgkmcnt(0)
    v_max3_u32 v136, v24, v28, v32
    v_max_u32 v136, v136, v36
    v_cmp_eq_u32 s[10:11], -1, v136
    s_cmp_eq_u64 s[10:11], 0
    s_cbranch_scc1 Lpd28
    s_and_b32 s13, s12, 7
    s_cselect_b32 s9, s99, s98
    s_sub_u32 s12, s12, 1
    s_cbranch_scc0 Lp27
Lpd28:
    v_mfma_f32_16x16x32_bf16 v[40:43], v[24:27], v[64:67], 0
    v_mfma_f32_16x16x32_bf16 v[44:47], v[24:27], v[68:71], 0
    v_mfma_f32_16x16x32_bf16 v[40:43], v[28:31], v[80:83], v[40:43]
    v_mfma_f32_16x16x32_bf16 v[44:47], v[28:31], v[84:87], v[44:47]
    v_mfma_f32_16x16x32_bf16 v[40:43], v[32:35], v[96:99], v[40:43]
    v_mfma_f32_16x16x32_bf16 v[44:47], v[32:35], v[100:103], v[44:47]
    v_mfma_f32_16x16x32_bf16 v[40:43], v[36:39], v[112:115], v[40:43]
    v_mfma_f32_16x16x32_bf16 v[44:47], v[36:39], v[116:119], v[44:47]
    v_mfma_f32_16x16x32_bf16 v[48:51], v[24:27], v[72:75], 0
    v_mfma_f32_16x16x32_bf16 v[52:55], v[24:27], v[76:79], 0
    v_mfma_f32_16x16x32_bf16 v[48:51], v[28:31], v[88:91], v[48:51]
    v_mfma_f32_16x16x32_bf16 v[52:55], v[28:31], v[92:95], v[52:55]
    v_mfma_f32_16x16x32_bf16 v[48:51], v[32:35], v[104:107], v[48:51]
    v_mfma_f32_16x16x32_bf16 v[52:55], v[32:35], v[108:111], v[52:55]
    v_mfma_f32_16x16x32_bf16 v[48:51], v[36:39], v[120:123], v[48:51]
    v_mfma_f32_16x16x32_bf16 v[52:55], v[36:39], v[124:127], v[52:55]
    v_pk_mul_f32 v[40:41], v[40:41], v[130:131]
    v_pk_mul_f32 v[44:45], v[44:45], v[130:131]
    v_pk_fma_f32 v[40:41], v[42:43], v[132:133], v[40:41]
    v_pk_fma_f32 v[44:45], v[46:47], v[132:133], v[44:45]
    v_add_f32 v40, v40, v41
    v_add_f32 v44, v44, v45
    s_nop 1
    v_permlane16_swap_b32 v40, v44
    v_add_f32 v40, v40, v44
    ds_write_b32 v15, v40 offset:0
    v_pk_mul_f32 v[48:49], v[48:49], v[130:131]
    v_pk_mul_f32 v[52:53], v[52:53], v[130:131]
    v_pk_fma_f32 v[48:49], v[50:51], v[132:133], v[48:49]
    v_pk_fma_f32 v[52:53], v[54:55], v[132:133], v[52:53]
    v_add_f32 v48, v48, v49
    v_add_f32 v52, v52, v53
    s_nop 1
    v_permlane16_swap_b32 v48, v52
    v_add_f32 v48, v48, v52
    ds_write_b32 v15, v48 offset:128
    s_waitcnt lgkmcnt(0)
    s_barrier
    s_cmp_eq_u32 s3, 0
    s_cbranch_scc0 LWe
    s_mov_b32 exec_hi, 0
    ds_read_b128 v[24:27], v18 offset:0
    ds_read_b128 v[28:31], v18 offset:512
    ds_read_b128 v[32:35], v18 offset:1024
    ds_read_b128 v[36:39], v18 offset:1536
    s_waitcnt lgkmcnt(2)
    v_pk_add_f32 v[24:25], v[24:25], v[28:29]
    v_pk_add_f32 v[26:27], v[26:27], v[30:31]
    s_waitcnt lgkmcnt(0)
    v_pk_add_f32 v[32:33], v[32:33], v[36:37]
    v_pk_add_f32 v[34:35], v[34:35], v[38:39]
    v_pk_add_f32 v[24:25], v[24:25], v[32:33]
    v_pk_add_f32 v[26:27], v[26:27], v[34:35]
    buffer_store_dwordx4 v[24:27], v17, s[40:43], s55 offen sc1
LWe:
    s_endpgm
LTpx:
    s_mov_b32 s95, 0x20000
    s_bitcmp1_b32 s3, 0
    s_cbranch_scc1 LTpd
    s_cmp_eq_u32 s3, 0
    s_cselect_b64 s[92:93], s[28:29], s[30:31]
    s_mov_b32 s94, 1835008
    s_mul_i32 s60, s5, 114688
    s_mul_i32 s61, s4, 448
    s_add_u32 s60, s60, s61
    s_add_u32 s61, s60, 57344
    v_lshrrev_b32 v236, 2, v0
    v_mul_u32_u24 v236, 3584, v236
    v_and_b32 v235, 3, v0
    v_lshl_add_u32 v236, v235, 7, v236
    s_branch LTpr
LTpd:
    s_mov_b64 s[92:93], s[32:33]
    s_mov_b32 s94, 1835008
    s_mul_i32 s60, s4, 229376
    s_lshl_b32 s61, s5, 1
    s_lshr_b32 s13, s3, 1
    s_add_u32 s61, s61, s13
    s_mul_i32 s61, s61, 7168
    s_add_u32 s60, s60, s61
    s_mov_b32 s61, 0x7fffffff
    v_min_u32 v236, 55, v0
    v_lshlrev_b32 v236, 7, v236
    s_branch LTpr
.p2align 12, , 3300
Lg30:
LT0:
    s_and_b32 s6, s5, 8
    s_add_u32 s6, s6, s4
    s_lshl_b32 s6, s6, 21
    s_and_b32 s8, s5, 7
    s_lshl_b32 s8, s8, 16
    s_add_u32 s6, s6, s8
    s_add_u32 s6, s6, s7
    s_add_u32 s6, s6, 1572864
    v_xor_b32 v2, v8, v1
    v_lshlrev_b32 v2, 4, v2
    v_lshl_add_u32 v2, v1, 8, v2
    v_xor_b32 v3, 64, v2
    v_xor_b32 v4, 0x80, v2
    v_xor_b32 v5, 0xc0, v2
    s_mov_b32 s8, s6
    s_add_u32 s9, s6, 16384
    s_mov_b32 s46, 0x2000000
    s_mov_b32 s50, 0x2000000
    s_add_u32 s10, s6, 8192
    s_waitcnt lgkmcnt(0)
    s_mov_b64 s[44:45], s[18:19]
    s_mov_b64 s[48:49], s[20:21]
    s_load_dword s14, s[40:41], 0
LTWk31:
    buffer_load_dwordx4 v2, s[44:47], s8 offen offset:0 nt lds
    buffer_load_dwordx4 v3, s[44:47], s8 offen offset:1024 nt lds
    buffer_load_dwordx4 v4, s[44:47], s8 offen offset:2048 nt lds
    buffer_load_dwordx4 v5, s[44:47], s8 offen offset:3072 nt lds
    s_add_u32 m0, m0, 4096
    s_add_u32 s8, s8, 4096
    s_cmp_lt_u32 s8, s10
    s_cbranch_scc1 LTWk31
    s_branch LTpx
LTpr:
LTWk32:
    buffer_load_dwordx4 v2, s[44:47], s8 offen offset:0 nt lds
    s_waitcnt vmcnt(8)
    buffer_load_dwordx4 v3, s[44:47], s8 offen offset:1024 nt lds
    s_waitcnt vmcnt(8)
    buffer_load_dwordx4 v4, s[44:47], s8 offen offset:2048 nt lds
    s_waitcnt vmcnt(8)
    buffer_load_dwordx4 v5, s[44:47], s8 offen offset:3072 nt lds
    s_waitcnt vmcnt(8)
    s_add_u32 m0, m0, 4096
    s_add_u32 s8, s8, 4096
    s_cmp_lt_u32 s8, s9
    s_cbranch_scc1 LTWk32
    s_lshl_b32 s55, s4, 14
    s_and_b32 s13, s5, 8
    s_lshl_b32 s13, s13, 10
    s_add_u32 s55, s55, s13
    s_lshl_b32 s13, s3, 11
    s_add_u32 s55, s55, s13
    s_add_u32 s55, s55, 1310720
    v_lshlrev_b32 v21, 4, v0
    v_mov_b32 v229, v21
    s_lshl_b32 s27, s4, 7
    s_add_u32 s27, s27, 6144
    s_add_u32 m0, s7, 65536
    s_mov_b32 s8, s6
    s_waitcnt lgkmcnt(0)
    s_mul_i32 s14, s14, 0x9E3779B1
    s_add_u32 s14, s14, 0x7F4A7C15
    buffer_load_dwordx4 v6, s[48:51], s8 offen offset:0 nt lds
    s_waitcnt vmcnt(8)
    buffer_load_dwordx4 v7, s[48:51], s8 offen offset:1024 nt lds
    s_waitcnt vmcnt(8)
    buffer_load_dwordx4 v6, s[48:51], s8 offen offset:2048 nt lds
    s_waitcnt vmcnt(8)
    buffer_load_dwordx4 v7, s[48:51], s8 offen offset:3072 nt lds
    s_waitcnt vmcnt(8)
    s_add_u32 m0, m0, 4096
    s_add_u32 s8, s8, 4096
    buffer_load_dwordx4 v6, s[48:51], s8 offen offset:0 nt lds
    s_waitcnt vmcnt(8)
    buffer_load_dwordx4 v7, s[48:51], s8 offen offset:1024 nt lds
    s_waitcnt vmcnt(8)
    buffer_load_dwordx4 v6, s[48:51], s8 offen offset:2048 nt lds
    s_waitcnt vmcnt(8)
    buffer_load_dwordx4 v7, s[48:51], s8 offen offset:3072 nt lds
    s_waitcnt vmcnt(8)
    s_add_u32 m0, m0, 4096
    s_add_u32 s8, s8, 4096
    s_mov_b64 exec, 0xff
    buffer_load_dword v237, v229, s[40:43], s27 offen sc1
    s_mov_b64 exec, -1
    buffer_load_dwordx4 v6, s[48:51], s8 offen offset:0 nt lds
    s_waitcnt vmcnt(8)
    buffer_load_dwordx4 v7, s[48:51], s8 offen offset:1024 nt lds
    s_waitcnt vmcnt(8)
    buffer_load_dwordx4 v6, s[48:51], s8 offen offset:2048 nt lds
    s_waitcnt vmcnt(8)
    buffer_load_dwordx4 v7, s[48:51], s8 offen offset:3072 nt lds
    s_waitcnt vmcnt(8)
    s_add_u32 m0, m0, 4096
    s_add_u32 s8, s8, 4096
    buffer_load_dwordx4 v6, s[48:51], s8 offen offset:0 nt lds
    s_waitcnt vmcnt(8)
    buffer_load_dwordx4 v7, s[48:51], s8 offen offset:1024 nt lds
    s_waitcnt vmcnt(8)
    buffer_load_dwordx4 v6, s[48:51], s8 offen offset:2048 nt lds
    s_waitcnt vmcnt(8)
    buffer_load_dwordx4 v7, s[48:51], s8 offen offset:3072 nt lds
    s_waitcnt vmcnt(8)
    s_waitcnt vmcnt(8)
    s_mov_b64 exec, 0xff
    v_cmp_ne_u32 vcc, s14, v237
    s_cbranch_vccz Lok33
    s_mov_b32 s12, 100000
Lp34:
    buffer_load_dword v237, v229, s[40:43], s27 offen sc1
    s_waitcnt vmcnt(0)
    v_cmp_ne_u32 s[10:11], s14, v237
    s_cmp_eq_u64 s[10:11], 0
    s_cbranch_scc1 Lpd35
    s_sleep 2
    s_sub_u32 s12, s12, 1
    s_cbranch_scc0 Lp34
Lpd35:
Lok33:
    s_mov_b64 exec, -1
    buffer_load_dwordx4 v[192:195], v21, s[40:43], s55 offen offset:0 sc1
    buffer_load_dwordx4 v[196:199], v21, s[40:43], s55 offen offset:1024 sc1
    v_lshlrev_b32 v22, 2, v8
    v_lshrrev_b32 v23, 5, v0
    v_lshl_add_u32 v22, v23, 1, v22
    v_and_b32 v23, 16, v0
    v_lshl_add_u32 v22, v23, 3, v22
    s_mul_i32 s13, s3, 272
    s_add_u32 s13, s13, 133632
    v_add_u32 v22, s13, v22
    v_xor_b32 v3, v8, v1
    v_lshlrev_b32 v3, 4, v3
    v_lshl_add_u32 v3, v8, 8, v3
    v_add_u32 v8, s7, v3
    v_xor_b32 v9, 64, v8
    v_xor_b32 v10, 0x80, v8
    v_xor_b32 v11, 0xc0, v8
    ds_read_b128 v[64:67], v8 offset:0
    ds_read_b128 v[68:71], v9 offset:0
    ds_read_b128 v[72:75], v10 offset:0
    ds_read_b128 v[76:79], v11 offset:0
    ds_read_b128 v[80:83], v8 offset:4096
    ds_read_b128 v[84:87], v9 offset:4096
    ds_read_b128 v[88:91], v10 offset:4096
    ds_read_b128 v[92:95], v11 offset:4096
    ds_read_b128 v[96:99], v8 offset:8192
    ds_read_b128 v[100:103], v9 offset:8192
    ds_read_b128 v[104:107], v10 offset:8192
    ds_read_b128 v[108:111], v11 offset:8192
    ds_read_b128 v[112:115], v8 offset:12288
    ds_read_b128 v[116:119], v9 offset:12288
    ds_read_b128 v[120:123], v10 offset:12288
    ds_read_b128 v[124:127], v11 offset:12288
    s_lshl_b32 s8, s3, 6
    v_lshrrev_b32 v3, 2, v0
    v_and_b32 v12, 7, v3
    v_lshlrev_b32 v12, 5, v12
    v_lshl_add_u32 v12, v3, 8, v12
    v_and_b32 v5, 3, v0
    v_lshl_add_u32 v12, v5, 3, v12
    v_xor_b32 v12, s8, v12
    v_add_u32 v12, 65536, v12
    v_xor_b32 v13, 32, v12
    v_mul_u32_u24 v20, 272, v5
    v_lshl_add_u32 v20, v1, 4, v20
    v_add_u32 v20, 133632, v20
    v_lshlrev_b32 v14, 6, v5
    v_lshl_add_u32 v14, v1, 4, v14
    v_add_u32 v14, 131072, v14
    s_lshl_b32 s9, s3, 9
    v_add_u32 v15, s9, v14
    v_lshlrev_b32 v16, 4, v5
    v_add_u32 v16, 133120, v16
    s_lshl_b32 s9, s3, 2
    v_add_u32 v17, s9, v16
    v_lshlrev_b32 v18, 8, v5
    v_lshl_add_u32 v18, v1, 4, v18
    v_lshlrev_b32 v19, 3, v5
    s_lshl_b32 s6, s4, 4
    s_add_u32 s6, s6, s5
    s_lshl_b32 s9, s6, 10
    s_add_u32 s8, s8, s9
    s_add_u32 s8, s8, 180224
    s_lshl_b32 s52, s6, 7
    s_add_u32 s52, s52, 163840
    s_add_u32 s53, s8, 147456
    s_add_u32 s54, s52, 147456
    s_mov_b32 s10, 0x3e0293ee
    s_lshl_b64 s[58:59], 1, s3
    v_mov_b32 v224, 0x3f803f80
    v_mov_b32 v225, 0x3f803f80
    v_mov_b32 v226, 0x3f803f80
    v_mov_b32 v227, 0x3f803f80
    v_bfe_u32 v3, v0, 2, 2
    v_lshl_add_u32 v14, v3, 9, v14
    v_lshl_add_u32 v234, v3, 2, v16
    v_lshrrev_b32 v4, 1, v3
    v_lshl_add_u32 v15, v4, 8, v15
    v_and_b32 v4, 1, v3
    v_lshl_add_u32 v15, v4, 3, v15
    s_mov_b32 s12, 100000
    s_barrier
    ds_read_b64_tr_b16 v[128:129], v12 offset:0
    ds_read_b64_tr_b16 v[130:131], v12 offset:4096
    ds_read_b64_tr_b16 v[132:133], v13 offset:0
    ds_read_b64_tr_b16 v[134:135], v13 offset:4096
    ds_read_b64_tr_b16 v[144:145], v12 offset:16384
    ds_read_b64_tr_b16 v[146:147], v12 offset:20480
    ds_read_b64_tr_b16 v[148:149], v13 offset:16384
    ds_read_b64_tr_b16 v[150:151], v13 offset:20480
    ds_read_b64_tr_b16 v[160:161], v12 offset:32768
    ds_read_b64_tr_b16 v[162:163], v12 offset:36864
    ds_read_b64_tr_b16 v[164:165], v13 offset:32768
    ds_read_b64_tr_b16 v[166:167], v13 offset:36864
    ds_read_b64_tr_b16 v[176:177], v12 offset:49152
    ds_read_b64_tr_b16 v[178:179], v12 offset:53248
    ds_read_b64_tr_b16 v[180:181], v13 offset:49152
    ds_read_b64_tr_b16 v[182:183], v13 offset:53248
    s_branch LTq1
LTq0:
    buffer_load_dwordx4 v[192:195], v21, s[40:43], s55 offen offset:0 sc1
    buffer_load_dwordx4 v[196:199], v21, s[40:43], s55 offen offset:1024 sc1
LTq1:
    s_waitcnt vmcnt(1)
    v_lshlrev_b32 v24, 16, v192
    v_and_b32 v25, 0xffff0000, v192
    v_lshlrev_b32 v26, 16, v193
    v_and_b32 v27, 0xffff0000, v193
    v_lshlrev_b32 v28, 16, v194
    v_and_b32 v29, 0xffff0000, v194
    v_lshlrev_b32 v30, 16, v195
    v_and_b32 v31, 0xffff0000, v195
    s_waitcnt vmcnt(0)
    v_lshlrev_b32 v32, 16, v196
    v_and_b32 v33, 0xffff0000, v196
    v_lshlrev_b32 v34, 16, v197
    v_and_b32 v35, 0xffff0000, v197
    v_lshlrev_b32 v36, 16, v198
    v_and_b32 v37, 0xffff0000, v198
    v_lshlrev_b32 v38, 16, v199
    v_and_b32 v39, 0xffff0000, v199
    v_pk_add_f32 v[24:25], v[24:25], v[32:33]
    v_pk_add_f32 v[26:27], v[26:27], v[34:35]
    v_pk_add_f32 v[28:29], v[28:29], v[36:37]
    v_pk_add_f32 v[30:31], v[30:31], v[38:39]
    s_nop 0
    v_permlane32_swap_b32 v24, v28
    v_permlane32_swap_b32 v25, v29
    v_permlane32_swap_b32 v26, v30
    v_permlane32_swap_b32 v27, v31
    v_pk_add_f32 v[24:25], v[24:25], v[28:29]
    v_pk_add_f32 v[26:27], v[26:27], v[30:31]
    s_nop 1
    v_permlane16_swap_b32 v24, v26
    v_permlane16_swap_b32 v25, v27
    v_pk_add_f32 v[24:25], v[24:25], v[26:27]
    v_cmp_u_f32 vcc, v24, v25
    v_cvt_pk_bf16_f32 v24, v24, v25
    s_cbranch_vccz LTq2
    s_sub_u32 s12, s12, 1
    s_cbranch_scc0 LTq0
LTq2:
    ds_write_b16 v22, v24
    ds_write_b16_d16_hi v22, v24 offset:64
    s_waitcnt lgkmcnt(0)
    s_barrier
    ds_read_b128 v[208:211], v20 offset:0
    ds_read_b128 v[212:215], v20 offset:64
    ds_read_b128 v[216:219], v20 offset:128
    ds_read_b128 v[220:223], v20 offset:192
    ds_read_b64_tr_b16 v[136:137], v12 offset:8192
    ds_read_b64_tr_b16 v[138:139], v12 offset:12288
    ds_read_b64_tr_b16 v[140:141], v13 offset:8192
    buffer_load_dword v238, v236, s[92:95], s61 offen
    s_waitcnt lgkmcnt(3)
    v_mfma_f32_16x16x32_bf16 v[40:43], v[64:67], v[208:211], 0
    ds_read_b64_tr_b16 v[142:143], v13 offset:12288
    v_mfma_f32_16x16x32_bf16 v[40:43], v[68:71], v[212:215], v[40:43]
    ds_read_b64_tr_b16 v[152:153], v12 offset:24576
    v_mfma_f32_16x16x32_bf16 v[40:43], v[72:75], v[216:219], v[40:43]
    ds_read_b64_tr_b16 v[154:155], v12 offset:28672
    v_mfma_f32_16x16x32_bf16 v[40:43], v[76:79], v[220:223], v[40:43]
    ds_read_b64_tr_b16 v[156:157], v13 offset:24576
    v_mfma_f32_16x16x32_bf16 v[44:47], v[80:83], v[208:211], 0
    ds_read_b64_tr_b16 v[158:159], v13 offset:28672
    v_mfma_f32_16x16x32_bf16 v[44:47], v[84:87], v[212:215], v[44:47]
    ds_read_b64_tr_b16 v[168:169], v12 offset:40960
    v_mfma_f32_16x16x32_bf16 v[44:47], v[88:91], v[216:219], v[44:47]
    ds_read_b64_tr_b16 v[170:171], v12 offset:45056
    v_mfma_f32_16x16x32_bf16 v[44:47], v[92:95], v[220:223], v[44:47]
    ds_read_b64_tr_b16 v[172:173], v13 offset:40960
    v_mfma_f32_16x16x32_bf16 v[48:51], v[96:99], v[208:211], 0
    ds_read_b64_tr_b16 v[174:175], v13 offset:45056
    v_mfma_f32_16x16x32_bf16 v[48:51], v[100:103], v[212:215], v[48:51]
    ds_read_b64_tr_b16 v[184:185], v12 offset:57344
    v_max3_f32 v232, v40, v41, v42
    v_mfma_f32_16x16x32_bf16 v[48:51], v[104:107], v[216:219], v[48:51]
    ds_read_b64_tr_b16 v[186:187], v12 offset:61440
    v_mfma_f32_16x16x32_bf16 v[48:51], v[108:111], v[220:223], v[48:51]
    ds_read_b64_tr_b16 v[188:189], v13 offset:57344
    v_mfma_f32_16x16x32_bf16 v[52:55], v[112:115], v[208:211], 0
    ds_read_b64_tr_b16 v[190:191], v13 offset:61440
    v_max3_f32 v232, v232, v43, v44
    v_max3_f32 v232, v232, v45, v46
    v_mfma_f32_16x16x32_bf16 v[52:55], v[116:119], v[212:215], v[52:55]
    v_mov_b32_dpp v40, v44 quad_perm:[0,1,2,3] row_mask:0xf bank_mask:0x2
    v_mov_b32_dpp v41, v45 quad_perm:[0,1,2,3] row_mask:0xf bank_mask:0x2
    v_mfma_f32_16x16x32_bf16 v[52:55], v[120:123], v[216:219], v[52:55]
    v_mov_b32_dpp v42, v46 quad_perm:[0,1,2,3] row_mask:0xf bank_mask:0x2
    v_mov_b32_dpp v43, v47 quad_perm:[0,1,2,3] row_mask:0xf bank_mask:0x2
    v_mfma_f32_16x16x32_bf16 v[52:55], v[124:127], v[220:223], v[52:55]
    v_max3_f32 v232, v232, v47, v48
    v_max3_f32 v232, v232, v49, v50
    v_mov_b32_dpp v40, v48 quad_perm:[0,1,2,3] row_mask:0xf bank_mask:0x4
    v_mov_b32_dpp v41, v49 quad_perm:[0,1,2,3] row_mask:0xf bank_mask:0x4
    v_mov_b32_dpp v42, v50 quad_perm:[0,1,2,3] row_mask:0xf bank_mask:0x4
    v_mov_b32_dpp v43, v51 quad_perm:[0,1,2,3] row_mask:0xf bank_mask:0x4
    s_nop 1
    v_max3_f32 v232, v232, v51, v52
    v_max3_f32 v233, v53, v54, v55
    v_max_f32 v232, v232, v233
    v_mov_b32 v233, v232
    v_mov_b32_dpp v40, v52 quad_perm:[0,1,2,3] row_mask:0xf bank_mask:0x8
    v_mov_b32_dpp v41, v53 quad_perm:[0,1,2,3] row_mask:0xf bank_mask:0x8
    v_permlane16_swap_b32 v232, v233
    v_max_f32 v232, v232, v233
    v_mov_b32 v233, v232
    v_mov_b32_dpp v42, v54 quad_perm:[0,1,2,3] row_mask:0xf bank_mask:0x8
    v_mov_b32_dpp v43, v55 quad_perm:[0,1,2,3] row_mask:0xf bank_mask:0x8
    v_permlane32_swap_b32 v232, v233
    v_max_f32 v232, v232, v233
    v_mul_f32 v230, 0xbe0293ee, v232
    v_fma_f32 v40, v40, s10, v230
    v_fma_f32 v41, v41, s10, v230
    v_fma_f32 v42, v42, s10, v230
    v_fma_f32 v43, v43, s10, v230
    ds_write_b32 v17, v230
    v_exp_f32 v40, v40
    v_exp_f32 v41, v41
    v_exp_f32 v42, v42
    v_exp_f32 v43, v43
    v_cvt_pk_bf16_f32 v44, v40, v41
    v_cvt_pk_bf16_f32 v45, v42, v43
    ds_write_b64 v15, v[44:45]
    s_waitcnt lgkmcnt(0)
    s_barrier
    ds_read_b128 v[64:67], v14 offset:0
    ds_read_b128 v[68:71], v14 offset:256
    ds_read_b32 v24, v234
    s_waitcnt lgkmcnt(1)
    v_mfma_f32_16x16x32_bf16 v[96:99], v[224:227], v[64:67], 0
    v_mfma_f32_16x16x32_bf16 v[96:99], v[224:227], v[68:71], v[96:99]
    v_mfma_f32_16x16x32_bf16 v[192:195], v[128:131], v[64:67], 0
    v_mfma_f32_16x16x32_bf16 v[196:199], v[132:135], v[64:67], 0
    s_waitcnt lgkmcnt(0)
    v_min_f32_dpp v32, v24, v24 row_ror:4 row_mask:0xf bank_mask:0xf
    v_mfma_f32_16x16x32_bf16 v[192:195], v[136:139], v[68:71], v[192:195]
    v_mfma_f32_16x16x32_bf16 v[196:199], v[140:143], v[68:71], v[196:199]
    v_min_f32_dpp v32, v32, v32 row_ror:8 row_mask:0xf bank_mask:0xf
    v_sub_f32 v24, v32, v24
    v_exp_f32 v24, v24
    v_mfma_f32_16x16x32_bf16 v[200:203], v[144:147], v[64:67], 0
    v_mfma_f32_16x16x32_bf16 v[204:207], v[148:151], v[64:67], 0
    v_mul_f32 v33, v24, v96
    v_mov_b32_dpp v25, v24 row_shl:4 row_mask:0xf bank_mask:0xf
    v_mov_b32_dpp v26, v24 row_shl:8 row_mask:0xf bank_mask:0xf
    v_mov_b32_dpp v27, v24 row_shl:12 row_mask:0xf bank_mask:0xf
    v_mfma_f32_16x16x32_bf16 v[200:203], v[152:155], v[68:71], v[200:203]
    v_mfma_f32_16x16x32_bf16 v[204:207], v[156:159], v[68:71], v[204:207]
    v_add_f32_dpp v33, v33, v33 row_ror:4 row_mask:0xf bank_mask:0xf
    v_pk_mul_f32 v[192:193], v[192:193], v[24:25] op_sel_hi:[1,0]
    v_pk_mul_f32 v[194:195], v[194:195], v[24:25] op_sel_hi:[1,0]
    v_pk_mul_f32 v[196:197], v[196:197], v[24:25] op_sel_hi:[1,0]
    v_pk_mul_f32 v[198:199], v[198:199], v[24:25] op_sel_hi:[1,0]
    v_mfma_f32_16x16x32_bf16 v[208:211], v[160:163], v[64:67], 0
    v_mfma_f32_16x16x32_bf16 v[212:215], v[164:167], v[64:67], 0
    v_add_f32_dpp v33, v33, v33 row_ror:8 row_mask:0xf bank_mask:0xf
    s_mov_b64 exec, s[58:59]
    buffer_store_dwordx2 v[32:33], v19, s[40:43], s54 offen
    s_mov_b64 exec, -1
    v_mfma_f32_16x16x32_bf16 v[208:211], v[168:171], v[68:71], v[208:211]
    v_mfma_f32_16x16x32_bf16 v[212:215], v[172:175], v[68:71], v[212:215]
    v_fmac_f32_dpp v192, v200, v25 row_shl:4 row_mask:0xf bank_mask:0xf
    v_fmac_f32_dpp v193, v201, v25 row_shl:4 row_mask:0xf bank_mask:0xf
    v_fmac_f32_dpp v194, v202, v25 row_shl:4 row_mask:0xf bank_mask:0xf
    v_fmac_f32_dpp v195, v203, v25 row_shl:4 row_mask:0xf bank_mask:0xf
    v_mfma_f32_16x16x32_bf16 v[216:219], v[176:179], v[64:67], 0
    v_mfma_f32_16x16x32_bf16 v[220:223], v[180:183], v[64:67], 0
    v_fmac_f32_dpp v196, v204, v25 row_shl:4 row_mask:0xf bank_mask:0xf
    v_fmac_f32_dpp v197, v205, v25 row_shl:4 row_mask:0xf bank_mask:0xf
    v_fmac_f32_dpp v198, v206, v25 row_shl:4 row_mask:0xf bank_mask:0xf
    v_fmac_f32_dpp v199, v207, v25 row_shl:4 row_mask:0xf bank_mask:0xf
    v_mfma_f32_16x16x32_bf16 v[216:219], v[184:187], v[68:71], v[216:219]
    v_mfma_f32_16x16x32_bf16 v[220:223], v[188:191], v[68:71], v[220:223]
    v_fmac_f32_dpp v192, v208, v26 row_shl:8 row_mask:0xf bank_mask:0xf
    v_fmac_f32_dpp v193, v209, v26 row_shl:8 row_mask:0xf bank_mask:0xf
    v_fmac_f32_dpp v194, v210, v26 row_shl:8 row_mask:0xf bank_mask:0xf
    v_fmac_f32_dpp v195, v211, v26 row_shl:8 row_mask:0xf bank_mask:0xf
    v_fmac_f32_dpp v196, v212, v26 row_shl:8 row_mask:0xf bank_mask:0xf
    v_fmac_f32_dpp v197, v213, v26 row_shl:8 row_mask:0xf bank_mask:0xf
    v_fmac_f32_dpp v198, v214, v26 row_shl:8 row_mask:0xf bank_mask:0xf
    v_fmac_f32_dpp v199, v215, v26 row_shl:8 row_mask:0xf bank_mask:0xf
    v_fmac_f32_dpp v192, v216, v27 row_shl:12 row_mask:0xf bank_mask:0xf
    v_fmac_f32_dpp v193, v217, v27 row_shl:12 row_mask:0xf bank_mask:0xf
    v_fmac_f32_dpp v194, v218, v27 row_shl:12 row_mask:0xf bank_mask:0xf
    v_fmac_f32_dpp v195, v219, v27 row_shl:12 row_mask:0xf bank_mask:0xf
    v_fmac_f32_dpp v196, v220, v27 row_shl:12 row_mask:0xf bank_mask:0xf
    v_fmac_f32_dpp v197, v221, v27 row_shl:12 row_mask:0xf bank_mask:0xf
    v_fmac_f32_dpp v198, v222, v27 row_shl:12 row_mask:0xf bank_mask:0xf
    v_fmac_f32_dpp v199, v223, v27 row_shl:12 row_mask:0xf bank_mask:0xf
    s_mov_b32 exec_lo, 0xf000f
    s_mov_b32 exec_hi, 0xf000f
    v_cvt_pk_bf16_f32 v200, v192, v193
    v_cvt_pk_bf16_f32 v201, v194, v195
    v_cvt_pk_bf16_f32 v202, v196, v197
    v_cvt_pk_bf16_f32 v203, v198, v199
    buffer_store_dwordx4 v[200:203], v18, s[40:43], s53 offen
    s_mov_b64 exec, -1
    s_barrier
    buffer_load_dword v237, v236, s[92:95], s60 offen
    s_mov_b32 exec_lo, 0xf000f
    s_mov_b32 exec_hi, 0xf000f
    buffer_store_dwordx4 v[200:203], v18, s[40:43], s8 offen sc1
    s_mov_b64 exec, s[58:59]
    buffer_store_dwordx2 v[32:33], v19, s[40:43], s52 offen sc1
    s_mov_b64 exec, -1
    s_cmp_eq_u32 s3, 1
    s_cbranch_scc0 LTWe
    s_cmp_lt_u32 s5, 4
    s_cbranch_scc0 LTWe
    s_lshl_b32 s6, s4, 2
    s_add_u32 s6, s6, s5
    s_mov_b64 s[44:45], s[16:17]
    s_mov_b32 s46, 2048
    s_mov_b32 s47, 0x20000
    s_mov_b64 s[48:49], s[38:39]
    s_mov_b32 s50, 2048
    s_mov_b32 s51, 0x20000
    v_bfe_u32 v2, v0, 2, 1
    v_and_b32 v3, 3, v0
    v_lshlrev_b32 v4, 3, v3
    v_lshl_add_u32 v5, v2, 10, v4
    v_lshlrev_b32 v6, 1, v5
    v_lshrrev_b32 v8, 3, v0
    v_lshl_add_u32 v7, v8, 12, v6
    v_lshlrev_b32 v9, 4, v0
    s_lshl_b32 s7, s6, 5
    s_lshl_b32 s8, s6, 6
    s_add_u32 s9, s8, 131072
    s_add_u32 s52, s8, 16384
    s_add_u32 s53, s8, 28672
    s_mul_i32 s54, s6, 7168
    s_add_u32 s54, s54, 458752
    s_add_u32 s55, s54, 4096
    buffer_load_dwordx2 v[10:11], v5, s[44:47], s7 offen
    s_mov_b32 s27, 4096
    s_mov_b32 s12, 100000
Lp36:
    buffer_load_dword v40, v9, s[40:43], s27 offen offset:0 sc1
    buffer_load_dword v41, v9, s[40:43], s27 offen offset:1024 sc1
    buffer_load_dword v42, v9, s[40:43], s27 offen offset:2048 sc1
    buffer_load_dword v43, v9, s[40:43], s27 offen offset:3072 sc1
    buffer_load_dwordx4 v[12:15], v6, s[40:43], s52 offen sc1
    buffer_load_dwordx4 v[16:19], v6, s[40:43], s53 offen sc1
    s_waitcnt vmcnt(5)
    v_cmp_ne_u32 s[10:11], s14, v40
    s_waitcnt vmcnt(4)
    v_cmp_ne_u32 vcc, s14, v41
    s_or_b64 s[10:11], s[10:11], vcc
    s_waitcnt vmcnt(3)
    v_cmp_ne_u32 vcc, s14, v42
    s_or_b64 s[10:11], s[10:11], vcc
    s_waitcnt vmcnt(2)
    v_cmp_ne_u32 vcc, s14, v43
    s_or_b64 s[10:11], s[10:11], vcc
    s_waitcnt vmcnt(1)
    v_cmp_ne_u32 vcc, s14, v14
    s_or_b64 s[10:11], s[10:11], vcc
    s_waitcnt vmcnt(0)
    v_cmp_ne_u32 vcc, s14, v18
    s_or_b64 s[10:11], s[10:11], vcc
    s_cmp_eq_u64 s[10:11], 0
    s_cbranch_scc1 Lpd37
    s_sleep 2
    s_sub_u32 s12, s12, 1
    s_cbranch_scc0 Lp36
Lpd37:
    v_lshlrev_b32 v22, 7, v0
    v_add_u32 v22, 8192, v22
    s_mov_b32 s12, 100000
Lp38:
    buffer_load_dwordx4 v[24:27], v7, s[40:43], s9 offen sc1
    s_waitcnt vmcnt(0)
    v_cmp_eq_u32 s[10:11], -1, v24
    s_cmp_eq_u64 s[10:11], 0
    s_cbranch_scc1 Lpd39
    s_sleep 2
    s_sub_u32 s12, s12, 1
    s_cbranch_scc0 Lp38
Lpd39:
    s_cmp_eq_u32 s6, 0
    s_cbranch_scc0 LTWn
    s_mov_b64 exec, 1
    v_mov_b32 v20, s14
    v_mov_b32 v21, 0
    buffer_store_dword v20, v21, s[40:43], 0 offen offset:0 sc1
    s_mov_b64 exec, -1
LTWn:
    v_add_f32_dpp v24, v24, v24 row_ror:8 row_mask:0xf bank_mask:0xf
    v_add_f32_dpp v25, v25, v25 row_ror:8 row_mask:0xf bank_mask:0xf
    v_add_f32_dpp v26, v26, v26 row_ror:8 row_mask:0xf bank_mask:0xf
    v_add_f32_dpp v27, v27, v27 row_ror:8 row_mask:0xf bank_mask:0xf
    v_mov_b32 v60, v24
    v_mov_b32 v61, v25
    v_mov_b32 v62, v26
    v_mov_b32 v63, v27
    v_permlane16_swap_b32 v24, v60
    v_permlane16_swap_b32 v25, v61
    v_permlane16_swap_b32 v26, v62
    v_permlane16_swap_b32 v27, v63
    v_add_f32 v24, v24, v60
    v_add_f32 v25, v25, v61
    v_add_f32 v26, v26, v62
    v_add_f32 v27, v27, v63
    v_mov_b32 v60, v24
    v_mov_b32 v61, v25
    v_mov_b32 v62, v26
    v_mov_b32 v63, v27
    v_permlane32_swap_b32 v24, v60
    v_permlane32_swap_b32 v25, v61
    v_permlane32_swap_b32 v26, v62
    v_permlane32_swap_b32 v27, v63
    v_add_f32 v24, v24, v60
    v_add_f32 v25, v25, v61
    v_add_f32 v26, v26, v62
    v_add_f32 v27, v27, v63
    v_lshlrev_b32 v28, 16, v10
    v_and_b32 v29, 0xffff0000, v10
    v_lshlrev_b32 v30, 16, v11
    v_and_b32 v31, 0xffff0000, v11
    v_lshlrev_b32 v32, 16, v12
    v_and_b32 v33, 0xffff0000, v12
    v_lshlrev_b32 v34, 16, v13
    v_and_b32 v35, 0xffff0000, v13
    v_lshlrev_b32 v36, 16, v16
    v_and_b32 v37, 0xffff0000, v16
    v_lshlrev_b32 v38, 16, v17
    v_and_b32 v39, 0xffff0000, v17
    v_fmac_f32 v28, v24, v32
    v_fmac_f32 v29, v25, v33
    v_fmac_f32 v30, v26, v34
    v_fmac_f32 v31, v27, v35
    v_mov_b32_dpp v28, v29 quad_perm:[0,1,2,3] row_mask:0x2 bank_mask:0xf
    v_mov_b32_dpp v36, v37 quad_perm:[0,1,2,3] row_mask:0x2 bank_mask:0xf
    s_nop 0
    v_mov_b32_dpp v28, v30 quad_perm:[0,1,2,3] row_mask:0x4 bank_mask:0xf
    v_mov_b32_dpp v36, v38 quad_perm:[0,1,2,3] row_mask:0x4 bank_mask:0xf
    s_nop 0
    v_mov_b32_dpp v28, v31 quad_perm:[0,1,2,3] row_mask:0x8 bank_mask:0xf
    v_mov_b32_dpp v36, v39 quad_perm:[0,1,2,3] row_mask:0x8 bank_mask:0xf
    v_lshrrev_b32 v4, 4, v0
    v_lshl_add_u32 v5, v4, 1, v5
    s_mov_b64 exec, 0xff
    s_mov_b32 s12, 100000
Lp40:
    buffer_load_dword v23, v22, s[40:43], 0 offen offset:1024 sc1
    s_waitcnt vmcnt(0)
    v_cmp_ne_u32 s[10:11], s14, v23
    s_cmp_eq_u64 s[10:11], 0
    s_cbranch_scc1 Lpd41
    s_sub_u32 s12, s12, 1
    s_cbranch_scc0 Lp40
Lpd41:
    s_mov_b64 exec, -1
    s_mov_b32 s12, 100000
Lp42:
    buffer_load_dwordx4 v[64:67], v9, s[40:43], s54 offen offset:0 sc1
    buffer_load_dwordx4 v[68:71], v9, s[40:43], s54 offen offset:1024 sc1
    buffer_load_dwordx4 v[72:75], v9, s[40:43], s54 offen offset:2048 sc1
    buffer_load_dwordx4 v[76:79], v9, s[40:43], s54 offen offset:3072 sc1
    buffer_load_dwordx4 v[80:83], v9, s[40:43], s55 offen offset:0 sc1
    buffer_load_dwordx4 v[84:87], v9, s[40:43], s55 offen offset:1024 sc1
    buffer_load_dwordx4 v[88:91], v9, s[40:43], s55 offen offset:2048 sc1
    s_waitcnt vmcnt(5)
    v_pk_add_f32 v[56:57], v[64:65], v[68:69]
    v_pk_add_f32 v[58:59], v[66:67], v[70:71]
    s_waitcnt vmcnt(4)
    v_pk_add_f32 v[56:57], v[56:57], v[72:73]
    v_pk_add_f32 v[58:59], v[58:59], v[74:75]
    s_waitcnt vmcnt(3)
    v_pk_add_f32 v[56:57], v[56:57], v[76:77]
    v_pk_add_f32 v[58:59], v[58:59], v[78:79]
    s_waitcnt vmcnt(2)
    v_pk_add_f32 v[56:57], v[56:57], v[80:81]
    v_pk_add_f32 v[58:59], v[58:59], v[82:83]
    s_waitcnt vmcnt(1)
    v_pk_add_f32 v[56:57], v[56:57], v[84:85]
    v_pk_add_f32 v[58:59], v[58:59], v[86:87]
    s_waitcnt vmcnt(0)
    v_pk_add_f32 v[56:57], v[56:57], v[88:89]
    v_pk_add_f32 v[58:59], v[58:59], v[90:91]
    v_cmp_u_f32 s[10:11], v56, v57
    v_cmp_u_f32 vcc, v58, v59
    s_or_b64 s[10:11], s[10:11], vcc
    s_cmp_eq_u64 s[10:11], 0
    s_cbranch_scc1 Lpd43
    s_sub_u32 s12, s12, 1
    s_cbranch_scc0 Lp42
Lpd43:
    v_permlane32_swap_b32 v56, v58
    v_permlane32_swap_b32 v57, v59
    v_pk_add_f32 v[56:57], v[56:57], v[58:59]
    s_nop 1
    v_permlane16_swap_b32 v56, v57
    v_add_f32 v56, v56, v57
    s_nop 1
    v_add_f32_dpp v56, v56, v56 row_ror:8 row_mask:0xf bank_mask:0xf
    s_mov_b32 exec_lo, 0xff00ff
    s_mov_b32 exec_hi, 0xff00ff
    v_fmac_f32 v28, v56, v36
    v_cvt_pk_bf16_f32 v10, v28, v28
    buffer_store_short v10, v5, s[48:51], s7 offen
LTWe:
    s_endpgm
Lexit:
    s_endpgm
Lcode_end:
.section .rodata,"a"
.p2align 6
.amdhsa_kernel adaLN_cond__sliding_block_cached__glu_gated_reglu__decode_kernel
  .amdhsa_next_free_vgpr 240
  .amdhsa_next_free_sgpr 102
  .amdhsa_accum_offset 240
  .amdhsa_group_segment_fixed_size 0
  .amdhsa_kernarg_size 112
  .amdhsa_user_sgpr_count 2
  .amdhsa_user_sgpr_kernarg_segment_ptr 1
  .amdhsa_system_sgpr_workgroup_id_x 1
.end_amdhsa_kernel
```
